```python
import torch

def _softmax(x, axis=-1):
    return torch.softmax(x, dim=axis)
def _gelu(x):
    return torch.nn.functional.gelu(x, approximate="tanh")
def _silu(x):
    return torch.nn.functional.silu(x)
def _sigmoid(x):
    return torch.sigmoid(x)
def _layernorm(x, axis=-1, eps=1e-5):
    m = x.mean(dim=axis, keepdim=True)
    v = x.var(dim=axis, keepdim=True, unbiased=False)
    return (x - m) / torch.sqrt(v + eps)
def _scatter_add(tgt, idx, src, axis=0):
    return tgt.clone().index_add_(axis, idx, src)
def _segment_sum(src, seg, n):
    out = torch.zeros((n,) + src.shape[1:], dtype=src.dtype)
    return out.index_add_(0, seg, src)
def _pad(x, pw):
    flat = tuple(v for pair in reversed(pw) for v in pair)
    return torch.nn.functional.pad(x, flat)

kernel_name = 'gated_mix__compressed_kv_cla__dense_activation_silu__decode'

def setup_inputs():

    _w = (lambda a: (lambda t: t.to(torch.bfloat16) if t.is_floating_point() else t)(torch.as_tensor(a)))
    def _A_setup():
        B, H, Sq, Sk, D, M = 1, 32, 1, 4096, 128, 640
        Dc = 4 * D
        return {
            "x": _w((lambda *s: torch.randn(*s, dtype=torch.bfloat16) * 0.05)(B, Sq, M)),
            "c_kv": _w((lambda *s: torch.randn(*s, dtype=torch.bfloat16) * 0.2)(B, Sk, Dc)),
            "w_q": _w((lambda *s: torch.randn(*s, dtype=torch.bfloat16) * 3.2)(M, H, D) * (M ** -0.5)),
            "w_uk": _w((lambda *s: torch.randn(*s, dtype=torch.bfloat16) * 3.2)(Dc, H, D) * (Dc ** -0.5)),
            "w_uv": _w((lambda *s: torch.randn(*s, dtype=torch.bfloat16) * 0.2)(Dc, H, D) * (Dc ** -0.5)),
            "w_o": _w((lambda *s: torch.randn(*s, dtype=torch.bfloat16) * 0.2)(H, D, M) * ((H * D) ** -0.5)),
        }
    _A_in = _A_setup()

    def _B_setup():
        B, S, D, F = 1, 1, 640, 1728
        return {
            "x": _w((lambda *s: torch.randn(*s, dtype=torch.bfloat16) * 0.05)(B, S, D)),
            "w1": _w((lambda *s: torch.randn(*s, dtype=torch.bfloat16) * 0.05)(D, F) * (D ** -0.5)),
            "w2": _w((lambda *s: torch.randn(*s, dtype=torch.bfloat16) * 0.05)(F, D) * (F ** -0.5)),
        }
    _B_in = _B_setup()

    return {
        "A_x": _A_in["x"],
        "A_c_kv": _A_in["c_kv"],
        "A_w_q": _A_in["w_q"],
        "A_w_uk": _A_in["w_uk"],
        "A_w_uv": _A_in["w_uv"],
        "A_w_o": _A_in["w_o"],
        "B_x": _B_in["x"],
        "B_w1": _B_in["w1"],
        "B_w2": _B_in["w2"],
        "gate_w": _w((lambda *s: torch.randn(*s, dtype=torch.bfloat16) * 0.05)(640) * 16.0),
    }

def reference(A_x, A_c_kv, A_w_q, A_w_uk, A_w_uv, A_w_o, B_x, B_w1, B_w2, gate_w):
    def _A_ref(x, c_kv, w_q, w_uk, w_uv, w_o):
        B, Sq, M = x.shape[0], x.shape[1], x.shape[2]
        Sk = c_kv.shape[1]
        H, D = w_q.shape[1], w_q.shape[2]
        q = torch.einsum("bqm,mhd->bhqd", x, w_q)
        k = torch.einsum("bkc,chd->bhkd", c_kv, w_uk)
        v = torch.einsum("bkc,chd->bhkd", c_kv, w_uv)
        scores = torch.einsum("bhqd,bhkd->bhqk", q, k) * (D ** -0.5)
        off = Sk - Sq
        qi = torch.arange(Sq)[:, None]
        kj = torch.arange(Sk)[None, :]
        cmask = kj <= (qi + off)
        scores = torch.where(cmask[None, None], scores, -1e9)
        p = _softmax(scores, axis=-1)
        ctx = torch.einsum("bhqk,bhkd->bhqd", p, v)
        return torch.einsum("bhqd,hdm->bqm", ctx, w_o)

    def _B_ref(x, w1, w2):
        h = torch.einsum("bsd,df->bsf", x, w1)
        h = _silu(h)
        out = torch.einsum("bsf,fd->bsd", h, w2)
        return out

    x = A_x
    g = _sigmoid((x * gate_w).sum(-1, keepdims=True))
    a = _A_ref(x, A_c_kv, A_w_q, A_w_uk, A_w_uv, A_w_o)
    b = _B_ref(x, B_w1, B_w2)
    return g * a + (1 - g) * b
```

```asm
; @launch grid=(256,1,1) block=(512,1,1) lds=152064
.amdgcn_target "amdgcn-amd-amdhsa--gfx950"
.text
.globl gated_mix__compressed_kv_cla__dense_activation_silu__decode_kernel
.p2align 8
.type gated_mix__compressed_kv_cla__dense_activation_silu__decode_kernel,@function
gated_mix__compressed_kv_cla__dense_activation_silu__decode_kernel:
    s_cmp_ge_u32 s2, 256
    s_cbranch_scc1 L_end
    s_load_dwordx16 s[16:31], s[0:1], 0
    s_load_dwordx2 s[40:41], s[0:1], 96
    s_load_dwordx8 s[32:39], s[0:1], 64
    v_lshrrev_b32 v1, 6, v0
    v_and_b32 v0, 63, v0
    v_readfirstlane_b32 s3, v1
    s_cmp_lg_u32 s3, 3
    s_cbranch_scc1 L_nocpf
    s_cmp_ge_u32 s2, 16
    s_cbranch_scc1 L_nocpf
    s_getpc_b64 s[42:43]
    v_lshlrev_b32 v6, 6, v0
    v_add_u32 v7, 8192, v6
    global_load_dword v254, v6, s[42:43]
    global_load_dword v255, v7, s[42:43] offset:-4096
    global_load_dword v254, v7, s[42:43]
    v_add_u32 v7, 4096, v7
    s_mov_b32 exec_hi, 0
    global_load_dword v255, v7, s[42:43]
    s_mov_b32 exec_hi, -1
L_nocpf:
    s_and_b32 s4, s2, 7
    s_lshr_b32 s5, s2, 3
    v_and_b32 v3, 15, v0
    v_lshrrev_b32 v4, 4, v0
    v_lshrrev_b32 v1, 3, v0
    v_and_b32 v2, 7, v0
    v_mul_u32_u24 v6, 40, v4
    s_mul_i32 s8, s4, 160
    v_add_u32 v6, s8, v6
    v_mul_u32_u24 v5, 163840, v4
    v_lshl_add_u32 v5, v3, 4, v5
    s_mul_i32 s8, s4, 655360
    s_mov_b32 s9, s5
    s_lshl_b32 s10, s9, 8
    s_add_u32 s8, s8, s10
    s_mov_b32 s46, 5242880
    s_mov_b32 s47, 0x20000
    s_lshr_b32 s68, s2, 6
    s_cmp_eq_u32 s68, 2
    s_cselect_b32 s14, 2, 1
    s_cmp_ge_u32 s3, s14
    s_waitcnt lgkmcnt(0)
    s_mov_b32 s38, 4472832
    s_load_dwordx2 s[70:71], s[40:41], s38
    s_mov_b32 s38, 0
    s_cbranch_scc1 L_noP1a
    s_mov_b32 s44, s20
    s_mov_b32 s45, s21
    global_load_dwordx4 v[182:185], v6, s[16:17]
    global_load_dwordx4 v[186:189], v6, s[16:17] offset:16
    global_load_dwordx2 v[190:191], v6, s[16:17] offset:32
    s_cmp_lg_u32 s3, 0
    s_cbranch_scc1 L_nowq
    buffer_load_dwordx4 v[102:105], v5, s[44:47], s8 offen nt
    s_add_u32 s8, s8, 8192
    buffer_load_dwordx4 v[106:109], v5, s[44:47], s8 offen nt
    s_add_u32 s8, s8, 8192
    buffer_load_dwordx4 v[110:113], v5, s[44:47], s8 offen nt
    s_add_u32 s8, s8, 8192
    buffer_load_dwordx4 v[114:117], v5, s[44:47], s8 offen nt
    s_add_u32 s8, s8, 8192
    buffer_load_dwordx4 v[118:121], v5, s[44:47], s8 offen nt
    s_add_u32 s8, s8, 8192
    buffer_load_dwordx4 v[122:125], v5, s[44:47], s8 offen nt
    s_add_u32 s8, s8, 8192
    buffer_load_dwordx4 v[126:129], v5, s[44:47], s8 offen nt
    s_add_u32 s8, s8, 8192
    buffer_load_dwordx4 v[130:133], v5, s[44:47], s8 offen nt
    s_add_u32 s8, s8, 8192
    buffer_load_dwordx4 v[134:137], v5, s[44:47], s8 offen nt
    s_add_u32 s8, s8, 8192
    buffer_load_dwordx4 v[138:141], v5, s[44:47], s8 offen nt
    s_add_u32 s8, s8, 8192
    buffer_load_dwordx4 v[142:145], v5, s[44:47], s8 offen nt
    s_add_u32 s8, s8, 8192
    buffer_load_dwordx4 v[146:149], v5, s[44:47], s8 offen nt
    s_add_u32 s8, s8, 8192
    buffer_load_dwordx4 v[150:153], v5, s[44:47], s8 offen nt
    s_add_u32 s8, s8, 8192
    buffer_load_dwordx4 v[154:157], v5, s[44:47], s8 offen nt
    s_add_u32 s8, s8, 8192
    buffer_load_dwordx4 v[158:161], v5, s[44:47], s8 offen nt
    s_add_u32 s8, s8, 8192
    buffer_load_dwordx4 v[162:165], v5, s[44:47], s8 offen nt
    s_add_u32 s8, s8, 8192
    buffer_load_dwordx4 v[166:169], v5, s[44:47], s8 offen nt
    s_add_u32 s8, s8, 8192
    buffer_load_dwordx4 v[170:173], v5, s[44:47], s8 offen nt
    s_add_u32 s8, s8, 8192
    buffer_load_dwordx4 v[174:177], v5, s[44:47], s8 offen nt
    s_add_u32 s8, s8, 8192
    buffer_load_dwordx4 v[178:181], v5, s[44:47], s8 offen nt
    s_add_u32 s8, s8, 8192
L_nowq:
    s_barrier
L_noP1a:
    v_and_b32 v6, 1, v0
    v_lshlrev_b32 v6, 4, v6
    v_mov_b32 v7, 0xffff
    v_lshlrev_b32 v6, v6, v7
    v_lshrrev_b32 v7, 1, v2
    s_and_b32 s7, s5, 3
    s_bfe_u32 s6, s5, 0x20002
    s_lshl_b32 s6, s6, 3
    s_add_u32 s6, s6, s4
    s_and_b32 s15, s3, 3
    s_and_b32 s78, s5, 1
    s_bfe_u32 s79, s5, 0x20001
    s_lshl_b32 s79, s79, 3
    s_add_u32 s79, s79, s4
    s_and_b32 s69, s2, 63
    v_cmp_eq_u32 vcc, 0, v7
    s_nop 1
    v_cndmask_b32 v14, 0, v6, vcc
    v_cmp_eq_u32 vcc, 1, v7
    s_nop 1
    v_cndmask_b32 v15, 0, v6, vcc
    v_cmp_eq_u32 vcc, 2, v7
    s_nop 1
    v_cndmask_b32 v16, 0, v6, vcc
    v_cmp_eq_u32 vcc, 3, v7
    s_nop 1
    v_cndmask_b32 v17, 0, v6, vcc
    s_cmp_ge_u32 s3, s14
    s_cbranch_scc1 L_noP1b
    v_mov_b32 v8, 0x0c0c0c0c
    s_mov_b32 s12, 0x01000100
    s_mov_b32 s13, 0x03020302
    v_bfi_b32 v192, v14, s12, v8
    v_bfi_b32 v196, v14, s13, v8
    v_bfi_b32 v193, v15, s12, v8
    v_bfi_b32 v197, v15, s13, v8
    v_bfi_b32 v194, v16, s12, v8
    v_bfi_b32 v198, v16, s13, v8
    v_bfi_b32 v195, v17, s12, v8
    v_bfi_b32 v199, v17, s13, v8
    s_lshl_b32 s12, s9, 4
    s_add_u32 s12, s12, s4
    s_lshl_b32 s12, s12, 10
    v_and_b32 v9, 31, v0
    v_lshl_add_u32 v9, v9, 4, s12
    v_lshrrev_b32 v8, 5, v0
    v_lshl_add_u32 v9, v8, 13, v9
    s_cmp_eq_u32 s3, 0
    s_cbranch_scc1 L_xw
    s_waitcnt vmcnt(0)
L_xw:
    s_waitcnt vmcnt(20)
    v_perm_b32 v22, v182, v182, v192
    v_perm_b32 v23, v182, v182, v193
    v_perm_b32 v24, v182, v182, v194
    v_perm_b32 v25, v182, v182, v195
    v_perm_b32 v26, v182, v182, v196
    v_perm_b32 v27, v182, v182, v197
    v_perm_b32 v28, v182, v182, v198
    v_perm_b32 v29, v182, v182, v199
    v_perm_b32 v30, v183, v183, v192
    v_perm_b32 v31, v183, v183, v193
    v_perm_b32 v32, v183, v183, v194
    v_perm_b32 v33, v183, v183, v195
    v_perm_b32 v34, v183, v183, v196
    v_perm_b32 v35, v183, v183, v197
    v_perm_b32 v36, v183, v183, v198
    v_perm_b32 v37, v183, v183, v199
    v_perm_b32 v38, v184, v184, v192
    v_perm_b32 v39, v184, v184, v193
    v_perm_b32 v40, v184, v184, v194
    v_perm_b32 v41, v184, v184, v195
    v_perm_b32 v42, v184, v184, v196
    v_perm_b32 v43, v184, v184, v197
    v_perm_b32 v44, v184, v184, v198
    v_perm_b32 v45, v184, v184, v199
    v_perm_b32 v46, v185, v185, v192
    v_perm_b32 v47, v185, v185, v193
    v_perm_b32 v48, v185, v185, v194
    v_perm_b32 v49, v185, v185, v195
    v_perm_b32 v50, v185, v185, v196
    v_perm_b32 v51, v185, v185, v197
    v_perm_b32 v52, v185, v185, v198
    v_perm_b32 v53, v185, v185, v199
    v_perm_b32 v54, v186, v186, v192
    v_perm_b32 v55, v186, v186, v193
    v_perm_b32 v56, v186, v186, v194
    v_perm_b32 v57, v186, v186, v195
    v_perm_b32 v58, v186, v186, v196
    v_perm_b32 v59, v186, v186, v197
    v_perm_b32 v60, v186, v186, v198
    v_perm_b32 v61, v186, v186, v199
    v_perm_b32 v62, v187, v187, v192
    v_perm_b32 v63, v187, v187, v193
    v_perm_b32 v64, v187, v187, v194
    v_perm_b32 v65, v187, v187, v195
    v_perm_b32 v66, v187, v187, v196
    v_perm_b32 v67, v187, v187, v197
    v_perm_b32 v68, v187, v187, v198
    v_perm_b32 v69, v187, v187, v199
    v_perm_b32 v70, v188, v188, v192
    v_perm_b32 v71, v188, v188, v193
    v_perm_b32 v72, v188, v188, v194
    v_perm_b32 v73, v188, v188, v195
    v_perm_b32 v74, v188, v188, v196
    v_perm_b32 v75, v188, v188, v197
    v_perm_b32 v76, v188, v188, v198
    v_perm_b32 v77, v188, v188, v199
    v_perm_b32 v78, v189, v189, v192
    v_perm_b32 v79, v189, v189, v193
    v_perm_b32 v80, v189, v189, v194
    v_perm_b32 v81, v189, v189, v195
    v_perm_b32 v82, v189, v189, v196
    v_perm_b32 v83, v189, v189, v197
    v_perm_b32 v84, v189, v189, v198
    v_perm_b32 v85, v189, v189, v199
    v_perm_b32 v86, v190, v190, v192
    v_perm_b32 v87, v190, v190, v193
    v_perm_b32 v88, v190, v190, v194
    v_perm_b32 v89, v190, v190, v195
    v_perm_b32 v90, v190, v190, v196
    v_perm_b32 v91, v190, v190, v197
    v_perm_b32 v92, v190, v190, v198
    v_perm_b32 v93, v190, v190, v199
    v_perm_b32 v94, v191, v191, v192
    v_perm_b32 v95, v191, v191, v193
    v_perm_b32 v96, v191, v191, v194
    v_perm_b32 v97, v191, v191, v195
    v_perm_b32 v98, v191, v191, v196
    v_perm_b32 v99, v191, v191, v197
    v_perm_b32 v100, v191, v191, v198
    v_perm_b32 v101, v191, v191, v199
    s_waitcnt lgkmcnt(0)
    s_add_u32 s70, s70, 1
    s_add_u32 s71, s71, 0x9e3779b9
    v_mov_b32 v12, s70
    v_mov_b32 v13, s71
    s_cmp_lg_u32 s3, 0
    s_cbranch_scc1 L_noP1b
    s_waitcnt vmcnt(19)
    v_mfma_f32_16x16x32_bf16 v[18:21], v[22:25], v[102:105], 0
    s_waitcnt vmcnt(18)
    v_mfma_f32_16x16x32_bf16 v[18:21], v[26:29], v[106:109], v[18:21]
    s_waitcnt vmcnt(17)
    v_mfma_f32_16x16x32_bf16 v[18:21], v[30:33], v[110:113], v[18:21]
    s_waitcnt vmcnt(16)
    v_mfma_f32_16x16x32_bf16 v[18:21], v[34:37], v[114:117], v[18:21]
    s_waitcnt vmcnt(15)
    v_mfma_f32_16x16x32_bf16 v[18:21], v[38:41], v[118:121], v[18:21]
    s_waitcnt vmcnt(14)
    v_mfma_f32_16x16x32_bf16 v[18:21], v[42:45], v[122:125], v[18:21]
    s_waitcnt vmcnt(13)
    v_mfma_f32_16x16x32_bf16 v[18:21], v[46:49], v[126:129], v[18:21]
    s_waitcnt vmcnt(12)
    v_mfma_f32_16x16x32_bf16 v[18:21], v[50:53], v[130:133], v[18:21]
    s_waitcnt vmcnt(11)
    v_mfma_f32_16x16x32_bf16 v[18:21], v[54:57], v[134:137], v[18:21]
    s_waitcnt vmcnt(10)
    v_mfma_f32_16x16x32_bf16 v[18:21], v[58:61], v[138:141], v[18:21]
    s_waitcnt vmcnt(9)
    v_mfma_f32_16x16x32_bf16 v[18:21], v[62:65], v[142:145], v[18:21]
    s_waitcnt vmcnt(8)
    v_mfma_f32_16x16x32_bf16 v[18:21], v[66:69], v[146:149], v[18:21]
    s_waitcnt vmcnt(7)
    v_mfma_f32_16x16x32_bf16 v[18:21], v[70:73], v[150:153], v[18:21]
    s_waitcnt vmcnt(6)
    v_mfma_f32_16x16x32_bf16 v[18:21], v[74:77], v[154:157], v[18:21]
    s_waitcnt vmcnt(5)
    v_mfma_f32_16x16x32_bf16 v[18:21], v[78:81], v[158:161], v[18:21]
    s_waitcnt vmcnt(4)
    v_mfma_f32_16x16x32_bf16 v[18:21], v[82:85], v[162:165], v[18:21]
    s_waitcnt vmcnt(3)
    v_mfma_f32_16x16x32_bf16 v[18:21], v[86:89], v[166:169], v[18:21]
    s_waitcnt vmcnt(2)
    v_mfma_f32_16x16x32_bf16 v[18:21], v[90:93], v[170:173], v[18:21]
    s_waitcnt vmcnt(1)
    v_mfma_f32_16x16x32_bf16 v[18:21], v[94:97], v[174:177], v[18:21]
    s_waitcnt vmcnt(0)
    v_mfma_f32_16x16x32_bf16 v[18:21], v[98:101], v[178:181], v[18:21]
    s_nop 7
    v_cvt_pk_bf16_f32 v10, v18, v19
    v_cvt_pk_bf16_f32 v11, v20, v21
    global_store_dwordx4 v9, v[10:13], s[40:41] offset:512 sc1
L_noP1b:
    v_mov_b32 v18, -1
    v_mov_b32 v19, -1
    v_mov_b32 v20, -1
    v_mov_b32 v21, -1
    s_cmp_eq_u32 s68, 3
    s_cbranch_scc1 L_roleA
    s_cmp_lt_u32 s68, 2
    s_cbranch_scc1 L_roleO
    s_lshr_b32 s8, s79, 2
    s_lshl_b32 s8, s8, 14
    s_and_b32 s13, s79, 3
    s_lshl_b32 s13, s13, 11
    s_add_u32 s8, s8, s13
    s_lshl_b32 s13, s78, 10
    s_add_u32 s12, s8, s13
    s_add_u32 s12, s12, 1573376
    s_cmp_ge_u32 s3, 4
    s_cbranch_scc1 L_kK
    s_cmp_lt_u32 s3, 2
    s_cbranch_scc1 L_kH1
    s_cmp_lg_u32 s3, 3
    s_cbranch_scc1 L_kH2
    v_and_b32 v7, 31, v0
    v_lshl_add_u32 v7, v7, 4, s12
    v_lshrrev_b32 v8, 5, v0
    v_lshl_add_u32 v7, v8, 13, v7
    global_store_dwordx4 v7, v[18:21], s[40:41] sc1
    v_add_u32 v7, 0x20000, v7
    global_store_dwordx4 v7, v[18:21], s[40:41] sc1
    v_add_u32 v7, 0x20000, v7
    global_store_dwordx4 v7, v[18:21], s[40:41] sc1
    v_add_u32 v7, 0x20000, v7
    global_store_dwordx4 v7, v[18:21], s[40:41] sc1
    v_add_u32 v7, 0x20000, v7
    s_lshr_b32 s8, s69, 2
    s_lshl_b32 s8, s8, 14
    s_and_b32 s39, s69, 3
    s_lshl_b32 s39, s39, 11
    s_add_u32 s8, s8, s39
    s_add_u32 s8, s8, 1048576
    v_lshl_add_u32 v6, v0, 4, s8
    v_add_u32 v8, 8192, v6
    s_mov_b32 exec_lo, 0xffffff
    s_mov_b32 exec_hi, 0xffffff
    global_store_dwordx4 v6, v[18:21], s[40:41] sc1
    global_store_dwordx4 v6, v[18:21], s[40:41] offset:1024 sc1
    global_store_dwordx4 v8, v[18:21], s[40:41] sc1
    global_store_dwordx4 v8, v[18:21], s[40:41] offset:1024 sc1
    s_mov_b64 exec, -1
    s_branch L_kH0
L_kH2:
L_kH0:
    s_barrier
    s_waitcnt lgkmcnt(0)
    s_add_u32 s70, s70, 1
    s_add_u32 s71, s71, 0x9e3779b9
    v_mov_b32 v12, s70
    v_mov_b32 v13, s71
    s_and_b32 s13, s3, 1
    s_lshl_b32 s8, s13, 13
    s_add_u32 s12, s12, s8
    s_lshl_b32 s13, s13, 2
    s_add_u32 s13, s13, 66560
    v_mov_b32 v6, s13
    s_memtime s[24:25]
    s_waitcnt lgkmcnt(0)
    s_load_dword s22, s[40:41], s12 glc
    s_waitcnt lgkmcnt(0)
    s_memtime s[26:27]
    s_waitcnt lgkmcnt(0)
    s_sub_u32 s22, s26, s24
    v_mov_b32 v7, s22
    ds_write_b32 v6, v7
    s_waitcnt vmcnt(0) lgkmcnt(0)
    s_cmp_lg_u32 s3, 3
    s_cbranch_scc1 L_kH1
    s_barrier
    v_mov_b32 v6, 66560
    ds_read_b64 v[8:9], v6
    s_lshl_b32 s8, s69, 4
    s_add_u32 s8, s8, 4456448
    v_mov_b32 v6, s8
    s_lshr_b32 s21, s4, 2
    s_waitcnt lgkmcnt(0)
    v_cmp_gt_u32 vcc, v8, v9
    s_nop 1
    v_cndmask_b32 v10, 0, 1, vcc
    v_xor_b32 v10, s21, v10
    s_mov_b64 exec, 1
    global_store_dwordx4 v6, v[10:13], s[40:41] sc1
    s_mov_b64 exec, -1
    s_branch L_kJ
L_kH1:
    s_barrier
    s_branch L_kJ
L_kK:
    s_mov_b32 s48, s22
    s_mov_b32 s49, s23
    s_mov_b32 s50, 4194304
    s_mov_b32 s51, 0x20000
    v_xor_b32 v6, v3, v4
    v_lshlrev_b32 v7, 15, v4
    v_lshl_add_u32 v200, v6, 4, v7
    v_xor_b32 v201, 64, v200
    v_xor_b32 v202, 128, v200
    v_xor_b32 v203, 192, v200
    s_lshl_b32 s10, s78, 21
    s_lshl_b32 s11, s15, 19
    s_add_u32 s10, s10, s11
    s_lshl_b32 s11, s79, 8
    s_add_u32 s10, s10, s11
    s_lshl_b32 s11, s15, 14
    s_add_u32 s11, s11, 1024
    s_barrier
    s_mov_b32 m0, s11
    s_add_u32 s11, s11, 1024
    buffer_load_dwordx4 v200, s[48:51], s10 offen lds
    s_add_u32 s10, s10, 0x20000
    s_mov_b32 m0, s11
    s_add_u32 s11, s11, 1024
    buffer_load_dwordx4 v201, s[48:51], s10 offen lds
    s_add_u32 s10, s10, 0x20000
    s_mov_b32 m0, s11
    s_add_u32 s11, s11, 1024
    buffer_load_dwordx4 v202, s[48:51], s10 offen lds
    s_add_u32 s10, s10, 0x20000
    s_mov_b32 m0, s11
    s_add_u32 s11, s11, 1024
    buffer_load_dwordx4 v203, s[48:51], s10 offen lds
    s_add_u32 s10, s10, 0xfffa2000
    s_waitcnt lgkmcnt(0)
    s_add_u32 s70, s70, 1
    s_add_u32 s71, s71, 0x9e3779b9
    v_mov_b32 v12, s70
    v_mov_b32 v13, s71
    s_lshl_b32 s13, s15, 7
    s_add_u32 s8, s12, s13
    v_lshl_add_u32 v205, v3, 3, s8
    v_lshl_add_u32 v205, v4, 17, v205
    v_add_u32 v206, 0x2000, v205
    v_and_b32 v134, 1, v4
    v_cmp_eq_u32 vcc, 1, v134
    s_nop 1
    v_cndmask_b32 v138, v14, v16, vcc
    v_cndmask_b32 v139, v15, v17, vcc
    v_and_b32 v138, 0x3f803f80, v138
    v_and_b32 v139, 0x3f803f80, v139
    s_lshl_b32 s8, s15, 8
    v_lshl_add_u32 v135, v3, 4, s8
    v_lshl_add_u32 v135, v4, 3, v135
    v_lshl_add_u32 v136, v4, 4, s8
    s_lshl_b32 s8, s15, 14
    s_add_u32 s8, s8, 1024
    v_xor_b32 v6, v3, v4
    v_lshl_add_u32 v7, v3, 8, s8
    v_lshl_add_u32 v6, v6, 4, v7
    v_xor_b32 v7, 64, v6
    v_xor_b32 v8, 128, v6
    v_xor_b32 v9, 192, v6
    s_lshl_b32 s8, s79, 14
    s_add_u32 s8, s8, 4608
    v_lshl_add_u32 v134, v0, 4, s8
    v_lshrrev_b32 v137, 5, v0
    v_lshl_add_u32 v134, v137, 9, v134
    s_mov_b32 s13, 0
    s_barrier
    v_mov_b32 v102, 66560
    ds_read_b64 v[102:103], v102
    s_mov_b32 m0, s11
    s_add_u32 s11, s11, 1024
    buffer_load_dwordx4 v200, s[48:51], s10 offen lds
    s_add_u32 s10, s10, 0x20000
    s_mov_b32 m0, s11
    s_add_u32 s11, s11, 1024
    buffer_load_dwordx4 v201, s[48:51], s10 offen lds
    s_add_u32 s10, s10, 0x20000
    s_mov_b32 m0, s11
    s_add_u32 s11, s11, 1024
    buffer_load_dwordx4 v202, s[48:51], s10 offen lds
    s_add_u32 s10, s10, 0x20000
    s_mov_b32 m0, s11
    s_add_u32 s11, s11, 1024
    buffer_load_dwordx4 v203, s[48:51], s10 offen lds
    s_add_u32 s10, s10, 0xfffa2000
    s_mov_b32 m0, s11
    s_add_u32 s11, s11, 1024
    buffer_load_dwordx4 v200, s[48:51], s10 offen lds
    s_add_u32 s10, s10, 0x20000
    s_mov_b32 m0, s11
    s_add_u32 s11, s11, 1024
    buffer_load_dwordx4 v201, s[48:51], s10 offen lds
    s_add_u32 s10, s10, 0x20000
    s_mov_b32 m0, s11
    s_add_u32 s11, s11, 1024
    buffer_load_dwordx4 v202, s[48:51], s10 offen lds
    s_add_u32 s10, s10, 0x20000
    s_mov_b32 m0, s11
    s_add_u32 s11, s11, 1024
    buffer_load_dwordx4 v203, s[48:51], s10 offen lds
    s_add_u32 s10, s10, 0xfffa2000
    s_mov_b32 m0, s11
    s_add_u32 s11, s11, 1024
    buffer_load_dwordx4 v200, s[48:51], s10 offen lds
    s_add_u32 s10, s10, 0x20000
    s_mov_b32 m0, s11
    s_add_u32 s11, s11, 1024
    buffer_load_dwordx4 v201, s[48:51], s10 offen lds
    s_add_u32 s10, s10, 0x20000
    s_mov_b32 m0, s11
    s_add_u32 s11, s11, 1024
    buffer_load_dwordx4 v202, s[48:51], s10 offen lds
    s_add_u32 s10, s10, 0x20000
    s_mov_b32 m0, s11
    s_add_u32 s11, s11, 1024
    buffer_load_dwordx4 v203, s[48:51], s10 offen lds
    s_add_u32 s10, s10, 0xfffa2000
    s_waitcnt lgkmcnt(0)
    v_cmp_gt_u32 vcc, v102, v103
    v_add_u32 v102, 0x2000, v134
    s_nop 0
    v_cndmask_b32 v134, v134, v102, vcc
    s_waitcnt vmcnt(12) lgkmcnt(8)
    ds_read_b128 v[22:25], v6 offset:0
    ds_read_b128 v[26:29], v7 offset:0
    ds_read_b128 v[30:33], v8 offset:0
    ds_read_b128 v[34:37], v9 offset:0
    s_waitcnt vmcnt(8) lgkmcnt(8)
    ds_read_b128 v[38:41], v6 offset:4096
    ds_read_b128 v[42:45], v7 offset:4096
    ds_read_b128 v[46:49], v8 offset:4096
    ds_read_b128 v[50:53], v9 offset:4096
    global_load_dwordx4 v[86:89], v134, s[40:41] offset:-4096 sc1
    global_load_dwordx4 v[90:93], v134, s[40:41] offset:-2048 sc1
    global_load_dwordx4 v[94:97], v134, s[40:41] offset:0 sc1
    global_load_dwordx4 v[98:101], v134, s[40:41] offset:2048 sc1
    s_waitcnt vmcnt(8) lgkmcnt(8)
    ds_read_b128 v[54:57], v6 offset:8192
    ds_read_b128 v[58:61], v7 offset:8192
    ds_read_b128 v[62:65], v8 offset:8192
    ds_read_b128 v[66:69], v9 offset:8192
    s_waitcnt vmcnt(4) lgkmcnt(8)
    ds_read_b128 v[70:73], v6 offset:12288
    ds_read_b128 v[74:77], v7 offset:12288
    ds_read_b128 v[78:81], v8 offset:12288
    ds_read_b128 v[82:85], v9 offset:12288
    s_branch L_qpc
L_qpp:
    s_mov_b64 exec, s[72:73]
    global_load_dwordx4 v[86:89], v134, s[40:41] offset:-4096 sc1
    s_mov_b64 exec, s[74:75]
    global_load_dwordx4 v[90:93], v134, s[40:41] offset:-2048 sc1
    s_mov_b64 exec, s[76:77]
    global_load_dwordx4 v[94:97], v134, s[40:41] offset:0 sc1
    s_mov_b64 exec, s[66:67]
    global_load_dwordx4 v[98:101], v134, s[40:41] offset:2048 sc1
    s_mov_b64 exec, -1
L_qpc:
    s_add_u32 s13, s13, 1
    s_waitcnt vmcnt(0)
    v_mfma_f32_16x16x16_bf16 v[18:21], v[138:139], v[86:87], 0
    v_cmp_ne_u64 s[72:73], s[70:71], v[88:89]
    v_mfma_f32_16x16x16_bf16 v[18:21], v[138:139], v[90:91], v[18:21]
    v_cmp_ne_u64 s[74:75], s[70:71], v[92:93]
    v_mfma_f32_16x16x16_bf16 v[18:21], v[138:139], v[94:95], v[18:21]
    v_cmp_ne_u64 s[76:77], s[70:71], v[96:97]
    v_mfma_f32_16x16x16_bf16 v[18:21], v[138:139], v[98:99], v[18:21]
    v_cmp_ne_u64 s[66:67], s[70:71], v[100:101]
    s_nop 0
    s_or_b64 vcc, s[72:73], s[74:75]
    s_or_b64 vcc, vcc, s[76:77]
    s_or_b64 vcc, vcc, s[66:67]
    s_cmp_gt_u32 s13, 200000
    s_cbranch_scc1 L_qpo
    s_cbranch_vccnz L_qpp
L_qpo:
    v_cvt_pk_bf16_f32 v18, v18, v19
    v_cvt_pk_bf16_f32 v19, v20, v21
    s_mov_b32 exec_hi, 0
    ds_write_b64 v135, v[18:19]
    s_mov_b32 exec_hi, -1
    s_mov_b32 s13, 0x3e0293ee
    s_waitcnt lgkmcnt(0)
    ds_read_b128 v[102:105], v136 offset:0
    ds_read_b128 v[106:109], v136 offset:64
    ds_read_b128 v[110:113], v136 offset:128
    ds_read_b128 v[114:117], v136 offset:192
    s_waitcnt lgkmcnt(3)
    v_mfma_f32_16x16x32_bf16 v[118:121], v[102:105], v[22:25], 0
    v_mfma_f32_16x16x32_bf16 v[122:125], v[102:105], v[38:41], 0
    v_mfma_f32_16x16x32_bf16 v[126:129], v[102:105], v[54:57], 0
    v_mfma_f32_16x16x32_bf16 v[130:133], v[102:105], v[70:73], 0
    s_waitcnt lgkmcnt(2)
    v_mfma_f32_16x16x32_bf16 v[118:121], v[106:109], v[26:29], v[118:121]
    v_mfma_f32_16x16x32_bf16 v[122:125], v[106:109], v[42:45], v[122:125]
    v_mfma_f32_16x16x32_bf16 v[126:129], v[106:109], v[58:61], v[126:129]
    v_mfma_f32_16x16x32_bf16 v[130:133], v[106:109], v[74:77], v[130:133]
    s_waitcnt lgkmcnt(1)
    v_mfma_f32_16x16x32_bf16 v[118:121], v[110:113], v[30:33], v[118:121]
    v_mfma_f32_16x16x32_bf16 v[122:125], v[110:113], v[46:49], v[122:125]
    v_mfma_f32_16x16x32_bf16 v[126:129], v[110:113], v[62:65], v[126:129]
    v_mfma_f32_16x16x32_bf16 v[130:133], v[110:113], v[78:81], v[130:133]
    s_waitcnt lgkmcnt(0)
    v_mfma_f32_16x16x32_bf16 v[118:121], v[114:117], v[34:37], v[118:121]
    v_mfma_f32_16x16x32_bf16 v[122:125], v[114:117], v[50:53], v[122:125]
    v_mfma_f32_16x16x32_bf16 v[126:129], v[114:117], v[66:69], v[126:129]
    v_mfma_f32_16x16x32_bf16 v[130:133], v[114:117], v[82:85], v[130:133]
    s_nop 4
    v_mul_f32 v118, s13, v118
    v_mul_f32 v122, s13, v122
    v_mul_f32 v126, s13, v126
    v_mul_f32 v130, s13, v130
    v_cvt_pk_bf16_f32 v140, v118, v122
    v_cvt_pk_bf16_f32 v141, v126, v130
    global_store_dwordx2 v205, v[140:141], s[40:41] sc1
    global_store_dwordx2 v206, v[140:141], s[40:41] sc1
L_kJ:
    s_mov_b32 s60, s30
    s_mov_b32 s61, s31
    s_mov_b32 s62, 2211840
    s_mov_b32 s63, 0x20000
    s_mov_b32 s52, s32
    s_mov_b32 s53, s33
    s_mov_b32 s54, 2211840
    s_mov_b32 s55, 0x20000
    s_and_b32 s13, s3, 1
    s_lshl_b32 s13, s13, 3
    v_add_u32 v6, 0, v0
    v_mul_u32_u24 v7, 820, v6
    v_lshrrev_b32 v7, 16, v7
    v_lshl_add_u32 v7, v7, 1, s13
    v_xor_b32 v6, v6, v7
    v_lshlrev_b32 v200, 4, v6
    v_add_u32 v6, 64, v0
    v_mul_u32_u24 v7, 820, v6
    v_lshrrev_b32 v7, 16, v7
    v_lshl_add_u32 v7, v7, 1, s13
    v_xor_b32 v6, v6, v7
    v_lshlrev_b32 v201, 4, v6
    v_add_u32 v6, 128, v0
    v_mul_u32_u24 v7, 820, v6
    v_lshrrev_b32 v7, 16, v7
    v_lshl_add_u32 v7, v7, 1, s13
    v_xor_b32 v6, v6, v7
    v_lshlrev_b32 v202, 4, v6
    v_add_u32 v6, 192, v0
    v_mul_u32_u24 v7, 820, v6
    v_lshrrev_b32 v7, 16, v7
    v_lshl_add_u32 v7, v7, 1, s13
    v_xor_b32 v6, v6, v7
    v_lshlrev_b32 v203, 4, v6
    v_add_u32 v6, 256, v0
    v_mul_u32_u24 v7, 820, v6
    v_lshrrev_b32 v7, 16, v7
    v_lshl_add_u32 v7, v7, 1, s13
    v_xor_b32 v6, v6, v7
    v_lshlrev_b32 v204, 4, v6
    s_mul_i32 s42, s69, 40960
    s_mul_i32 s43, s3, 5120
    s_add_u32 s42, s42, s43
    s_add_u32 s43, s43, 1024
    v_mul_u32_u24 v5, 69120, v4
    v_lshl_add_u32 v5, v3, 4, v5
    s_and_b32 s9, s5, 7
    s_lshl_b32 s9, s9, 1
    s_add_u32 s9, s9, s3
    s_mul_i32 s14, s4, 276480
    s_lshl_b32 s8, s9, 8
    s_add_u32 s14, s14, s8
    s_lshl_b32 s9, s9, 3
    s_add_u32 s9, s9, s4
    s_lshl_b32 s9, s9, 10
    s_add_u32 s9, s9, 1442304
    v_lshl_add_u32 v207, v0, 4, s9
    s_barrier
    s_cmp_ge_u32 s69, 56
    s_cbranch_scc1 L_fin
    s_cmp_ge_u32 s3, 2
    s_cbranch_scc1 L_now1
    buffer_load_dwordx4 v[102:105], v5, s[60:63], s14 offen nt
    s_add_u32 s14, s14, 3456
    buffer_load_dwordx4 v[106:109], v5, s[60:63], s14 offen nt
    s_add_u32 s14, s14, 3456
    buffer_load_dwordx4 v[110:113], v5, s[60:63], s14 offen nt
    s_add_u32 s14, s14, 3456
    buffer_load_dwordx4 v[114:117], v5, s[60:63], s14 offen nt
    s_add_u32 s14, s14, 3456
    buffer_load_dwordx4 v[118:121], v5, s[60:63], s14 offen nt
    s_add_u32 s14, s14, 3456
    buffer_load_dwordx4 v[122:125], v5, s[60:63], s14 offen nt
    s_add_u32 s14, s14, 3456
    buffer_load_dwordx4 v[126:129], v5, s[60:63], s14 offen nt
    s_add_u32 s14, s14, 3456
    buffer_load_dwordx4 v[130:133], v5, s[60:63], s14 offen nt
    s_add_u32 s14, s14, 3456
    buffer_load_dwordx4 v[134:137], v5, s[60:63], s14 offen nt
    s_add_u32 s14, s14, 3456
    buffer_load_dwordx4 v[138:141], v5, s[60:63], s14 offen nt
    s_add_u32 s14, s14, 3456
    buffer_load_dwordx4 v[142:145], v5, s[60:63], s14 offen nt
    s_add_u32 s14, s14, 3456
    buffer_load_dwordx4 v[146:149], v5, s[60:63], s14 offen nt
    s_add_u32 s14, s14, 3456
    buffer_load_dwordx4 v[150:153], v5, s[60:63], s14 offen nt
    s_add_u32 s14, s14, 3456
    buffer_load_dwordx4 v[154:157], v5, s[60:63], s14 offen nt
    s_add_u32 s14, s14, 3456
    buffer_load_dwordx4 v[158:161], v5, s[60:63], s14 offen nt
    s_add_u32 s14, s14, 3456
    buffer_load_dwordx4 v[162:165], v5, s[60:63], s14 offen nt
    s_add_u32 s14, s14, 3456
    buffer_load_dwordx4 v[166:169], v5, s[60:63], s14 offen nt
    s_add_u32 s14, s14, 3456
    buffer_load_dwordx4 v[170:173], v5, s[60:63], s14 offen nt
    s_add_u32 s14, s14, 3456
    buffer_load_dwordx4 v[174:177], v5, s[60:63], s14 offen nt
    s_add_u32 s14, s14, 3456
    buffer_load_dwordx4 v[178:181], v5, s[60:63], s14 offen nt
    s_add_u32 s14, s14, 3456
L_now1:
    s_barrier
    s_cmp_ge_u32 s3, 2
    s_cbranch_scc1 L_now1b
    s_setprio 3
    s_waitcnt vmcnt(19)
    v_mfma_f32_16x16x32_bf16 v[18:21], v[22:25], v[102:105], 0
    s_waitcnt vmcnt(18)
    v_mfma_f32_16x16x32_bf16 v[18:21], v[26:29], v[106:109], v[18:21]
    s_waitcnt vmcnt(17)
    v_mfma_f32_16x16x32_bf16 v[18:21], v[30:33], v[110:113], v[18:21]
    s_waitcnt vmcnt(16)
    v_mfma_f32_16x16x32_bf16 v[18:21], v[34:37], v[114:117], v[18:21]
    s_waitcnt vmcnt(15)
    v_mfma_f32_16x16x32_bf16 v[18:21], v[38:41], v[118:121], v[18:21]
    s_waitcnt vmcnt(14)
    v_mfma_f32_16x16x32_bf16 v[18:21], v[42:45], v[122:125], v[18:21]
    s_waitcnt vmcnt(13)
    v_mfma_f32_16x16x32_bf16 v[18:21], v[46:49], v[126:129], v[18:21]
    s_waitcnt vmcnt(12)
    v_mfma_f32_16x16x32_bf16 v[18:21], v[50:53], v[130:133], v[18:21]
    s_waitcnt vmcnt(11)
    v_mfma_f32_16x16x32_bf16 v[18:21], v[54:57], v[134:137], v[18:21]
    s_waitcnt vmcnt(10)
    v_mfma_f32_16x16x32_bf16 v[18:21], v[58:61], v[138:141], v[18:21]
    s_waitcnt vmcnt(9)
    v_mfma_f32_16x16x32_bf16 v[18:21], v[62:65], v[142:145], v[18:21]
    s_waitcnt vmcnt(8)
    v_mfma_f32_16x16x32_bf16 v[18:21], v[66:69], v[146:149], v[18:21]
    s_waitcnt vmcnt(7)
    v_mfma_f32_16x16x32_bf16 v[18:21], v[70:73], v[150:153], v[18:21]
    s_waitcnt vmcnt(6)
    v_mfma_f32_16x16x32_bf16 v[18:21], v[74:77], v[154:157], v[18:21]
    s_waitcnt vmcnt(5)
    v_mfma_f32_16x16x32_bf16 v[18:21], v[78:81], v[158:161], v[18:21]
    s_waitcnt vmcnt(4)
    v_mfma_f32_16x16x32_bf16 v[18:21], v[82:85], v[162:165], v[18:21]
    s_waitcnt vmcnt(3)
    v_mfma_f32_16x16x32_bf16 v[18:21], v[86:89], v[166:169], v[18:21]
    s_waitcnt vmcnt(2)
    v_mfma_f32_16x16x32_bf16 v[18:21], v[90:93], v[170:173], v[18:21]
    s_waitcnt vmcnt(1)
    v_mfma_f32_16x16x32_bf16 v[18:21], v[94:97], v[174:177], v[18:21]
    s_waitcnt vmcnt(0)
    v_mfma_f32_16x16x32_bf16 v[18:21], v[98:101], v[178:181], v[18:21]
    s_nop 7
    v_cvt_pk_bf16_f32 v10, v18, v19
    v_cvt_pk_bf16_f32 v11, v20, v21
    s_mov_b32 exec_hi, 0
    global_store_dwordx4 v207, v[10:13], s[40:41] offset:0 sc1
    s_mov_b32 exec_hi, -1
    s_setprio 0
    s_branch L_w2d
L_now1b:
    s_mov_b32 s8, s3
L_w2l:
    s_mov_b32 m0, s43
    s_add_u32 s43, s43, 1024
    buffer_load_dwordx4 v200, s[52:55], s42 offen nt lds
    s_mov_b32 m0, s43
    s_add_u32 s43, s43, 1024
    buffer_load_dwordx4 v201, s[52:55], s42 offen nt lds
    s_mov_b32 m0, s43
    s_add_u32 s43, s43, 1024
    buffer_load_dwordx4 v202, s[52:55], s42 offen nt lds
    s_mov_b32 m0, s43
    s_add_u32 s43, s43, 1024
    buffer_load_dwordx4 v203, s[52:55], s42 offen nt lds
    s_mov_b32 m0, s43
    s_add_u32 s43, s43, 1024
    buffer_load_dwordx4 v204, s[52:55], s42 offen nt lds
    s_cmp_ge_u32 s8, 4
    s_cbranch_scc1 L_w2d
    s_mov_b32 s8, 4
    s_sub_u32 s42, s42, 10240
    s_sub_u32 s43, s43, 15360
    s_branch L_w2l
L_w2d:
    v_lshlrev_b32 v205, 4, v0
    v_add_u32 v205, 4456448, v205
    global_load_dwordx4 v[214:217], v205, s[40:41] sc1
    v_lshrrev_b32 v7, 2, v0
    v_and_b32 v9, 7, v7
    v_and_b32 v8, 3, v0
    v_mul_u32_u24 v7, 1280, v7
    v_lshl_add_u32 v7, v8, 3, v7
    v_add_u32 v7, 1024, v7
    s_mul_i32 s13, s3, 5
    v_xor_b32 v200, s13, v9
    v_lshl_add_u32 v200, v200, 5, v7
    s_add_u32 s13, s13, 1
    v_xor_b32 v201, s13, v9
    v_lshl_add_u32 v201, v201, 5, v7
    s_add_u32 s13, s13, 1
    v_xor_b32 v202, s13, v9
    v_lshl_add_u32 v202, v202, 5, v7
    s_add_u32 s13, s13, 1
    v_xor_b32 v203, s13, v9
    v_lshl_add_u32 v203, v203, 5, v7
    s_add_u32 s13, s13, 1
    v_xor_b32 v204, s13, v9
    v_lshl_add_u32 v204, v204, 5, v7
    s_add_u32 s13, s13, 1
    s_mov_b32 s26, 0xffff0000
    s_mov_b32 s27, 0xffff0000
    s_mov_b32 s28, 0
    s_mov_b32 s29, -1
    s_lshr_b32 s8, s69, 2
    s_lshl_b32 s8, s8, 13
    s_and_b32 s9, s69, 3
    s_lshl_b32 s9, s9, 6
    s_add_u32 s8, s8, s9
    s_add_u32 s8, s8, 1442304
    v_lshl_add_u32 v207, v2, 10, s8
    v_and_b32 v7, 1, v4
    v_lshl_add_u32 v207, v7, 8, v207
    v_lshrrev_b32 v7, 1, v4
    v_lshl_add_u32 v207, v7, 4, v207
    v_and_b32 v7, 1, v1
    v_lshl_add_u32 v207, v7, 5, v207
    s_lshr_b32 s8, s69, 2
    s_lshl_b32 s8, s8, 14
    s_and_b32 s9, s69, 3
    s_lshl_b32 s9, s9, 11
    s_add_u32 s8, s8, s9
    s_and_b32 s9, s3, 3
    s_lshl_b32 s9, s9, 9
    s_add_u32 s8, s8, s9
    s_lshr_b32 s9, s3, 2
    s_lshl_b32 s9, s9, 13
    s_add_u32 s8, s8, s9
    s_xor_b32 s8, s8, s38
    s_add_u32 s8, s8, 1048576
    v_lshl_add_u32 v208, v0, 2, s8
    s_waitcnt vmcnt(0)
    s_mov_b32 s13, 0
    s_branch L_vkc
L_vkp:
    global_load_dwordx4 v[214:217], v205, s[40:41] sc1
    s_waitcnt vmcnt(0)
L_vkc:
    s_add_u32 s13, s13, 1
    v_cmp_eq_u32 s[72:73], 1, v214
    v_cmp_ne_u64 vcc, s[70:71], v[216:217]
    s_cmp_gt_u32 s13, 200000
    s_cbranch_scc1 L_vko
    s_cbranch_vccnz L_vkp
L_vko:
    s_bcnt1_i32_b64 s38, s[72:73]
    s_cmp_gt_u32 s38, 32
    s_cselect_b32 s38, 0x2000, 0
    v_xor_b32 v208, s38, v208
    s_barrier
    s_cmp_ge_u32 s69, 54
    s_cbranch_scc1 L_fin
    global_load_dwordx4 v[210:213], v207, s[40:41] sc1
    ds_read_b64_tr_b16 v[102:103], v200 offset:0
    ds_read_b64_tr_b16 v[104:105], v200 offset:20480
    ds_read_b64_tr_b16 v[106:107], v201 offset:0
    ds_read_b64_tr_b16 v[108:109], v201 offset:20480
    ds_read_b64_tr_b16 v[110:111], v202 offset:0
    ds_read_b64_tr_b16 v[112:113], v202 offset:20480
    ds_read_b64_tr_b16 v[114:115], v203 offset:0
    ds_read_b64_tr_b16 v[116:117], v203 offset:20480
    ds_read_b64_tr_b16 v[118:119], v204 offset:0
    ds_read_b64_tr_b16 v[120:121], v204 offset:20480
    s_mov_b32 s13, 0
    s_branch L_hpc
L_hpp:
    s_mov_b64 exec, vcc
    global_load_dwordx4 v[210:213], v207, s[40:41] sc1
    s_mov_b64 exec, -1
L_hpc:
    s_add_u32 s13, s13, 1
    s_waitcnt vmcnt(0)
    v_cmp_ne_u64 vcc, s[70:71], v[212:213]
    s_cmp_gt_u32 s13, 200000
    s_cbranch_scc1 L_hpo
    s_cbranch_vccnz L_hpp
L_hpo:
    v_lshlrev_b32 v214, 16, v210
    v_and_b32 v215, 0xffff0000, v210
    v_lshlrev_b32 v216, 16, v211
    v_and_b32 v217, 0xffff0000, v211
    v_add_f32_dpp v214, v214, v214 quad_perm:[1,0,3,2] row_mask:0xf bank_mask:0xf
    v_add_f32_dpp v215, v215, v215 quad_perm:[1,0,3,2] row_mask:0xf bank_mask:0xf
    v_add_f32_dpp v216, v216, v216 quad_perm:[1,0,3,2] row_mask:0xf bank_mask:0xf
    v_add_f32_dpp v217, v217, v217 quad_perm:[1,0,3,2] row_mask:0xf bank_mask:0xf
    v_add_f32_dpp v214, v214, v214 quad_perm:[2,3,0,1] row_mask:0xf bank_mask:0xf
    v_add_f32_dpp v215, v215, v215 quad_perm:[2,3,0,1] row_mask:0xf bank_mask:0xf
    v_add_f32_dpp v216, v216, v216 quad_perm:[2,3,0,1] row_mask:0xf bank_mask:0xf
    v_add_f32_dpp v217, v217, v217 quad_perm:[2,3,0,1] row_mask:0xf bank_mask:0xf
    v_add_f32_dpp v214, v214, v214 row_half_mirror row_mask:0xf bank_mask:0xf
    v_add_f32_dpp v215, v215, v215 row_half_mirror row_mask:0xf bank_mask:0xf
    v_add_f32_dpp v216, v216, v216 row_half_mirror row_mask:0xf bank_mask:0xf
    v_add_f32_dpp v217, v217, v217 row_half_mirror row_mask:0xf bank_mask:0xf
    v_mul_f32 v218, 0xbfb8aa3b, v214
    v_mul_f32 v219, 0xbfb8aa3b, v215
    v_mul_f32 v220, 0xbfb8aa3b, v216
    v_mul_f32 v221, 0xbfb8aa3b, v217
    v_exp_f32 v218, v218
    v_exp_f32 v219, v219
    v_exp_f32 v220, v220
    v_exp_f32 v221, v221
    v_add_f32 v218, 1.0, v218
    v_add_f32 v219, 1.0, v219
    v_add_f32 v220, 1.0, v220
    v_add_f32 v221, 1.0, v221
    v_rcp_f32 v218, v218
    v_rcp_f32 v219, v219
    v_rcp_f32 v220, v220
    v_rcp_f32 v221, v221
    v_mul_f32 v214, v214, v218
    v_mul_f32 v215, v215, v219
    v_mul_f32 v216, v216, v220
    v_mul_f32 v217, v217, v221
    v_cvt_pk_bf16_f32 v222, v214, v215
    v_cvt_pk_bf16_f32 v223, v216, v217
    v_mov_b32 v224, v222
    v_mov_b32 v225, v223
    v_mov_b32_dpp v222, v222 row_ror:8 row_mask:0xf bank_mask:0xc
    v_mov_b32_dpp v223, v223 row_ror:8 row_mask:0xf bank_mask:0xc
    v_mov_b32_dpp v224, v224 row_ror:8 row_mask:0xf bank_mask:0x3
    v_mov_b32_dpp v225, v225 row_ror:8 row_mask:0xf bank_mask:0x3
    s_waitcnt lgkmcnt(0)
    s_nop 0
    v_mfma_f32_16x16x32_bf16 v[122:125], v[222:225], v[102:105], 0
    v_mfma_f32_16x16x32_bf16 v[126:129], v[222:225], v[106:109], 0
    v_mfma_f32_16x16x32_bf16 v[130:133], v[222:225], v[110:113], 0
    v_mfma_f32_16x16x32_bf16 v[134:137], v[222:225], v[114:117], 0
    v_mfma_f32_16x16x32_bf16 v[138:141], v[222:225], v[118:121], 0
    s_nop 4
    v_cndmask_b32 v122, v122, v126, s[26:27]
    s_nop 0
    v_cndmask_b32 v130, v130, v134, s[26:27]
    v_cndmask_b32 v122, v122, v130, s[28:29]
    global_store_dword v208, v122, s[40:41] sc1
    s_mov_b32 exec_hi, 0
    global_store_dword v208, v138, s[40:41] offset:256 sc1
    s_mov_b32 exec_hi, -1
    s_branch L_fin
L_roleO:
    s_cmp_lg_u32 s3, 2
    s_cbranch_scc1 L_o1
    s_lshr_b32 s8, s2, 2
    s_lshl_b32 s8, s8, 14
    s_and_b32 s39, s2, 3
    s_lshl_b32 s39, s39, 11
    s_add_u32 s8, s8, s39
    s_add_u32 s8, s8, 524288
    v_lshl_add_u32 v6, v0, 4, s8
    v_add_u32 v8, 8192, v6
    s_mov_b32 exec_lo, 0xffffff
    s_mov_b32 exec_hi, 0xffffff
    global_store_dwordx4 v6, v[18:21], s[40:41] sc1
    global_store_dwordx4 v6, v[18:21], s[40:41] offset:1024 sc1
    global_store_dwordx4 v8, v[18:21], s[40:41] sc1
    global_store_dwordx4 v8, v[18:21], s[40:41] offset:1024 sc1
    s_mov_b64 exec, -1
L_o1:
    s_mov_b32 s52, s24
    s_mov_b32 s53, s25
    s_mov_b32 s54, 4194304
    s_mov_b32 s55, 0x20000
    s_mov_b32 s56, s26
    s_mov_b32 s57, s27
    s_mov_b32 s58, 5242880
    s_mov_b32 s59, 0x20000
    s_lshr_b32 s13, s7, 1
    s_and_b32 s10, s3, 1
    s_lshl_b32 s10, s10, 2
    v_xor_b32 v6, s10, v2
    v_and_b32 v7, 4, v1
    v_and_b32 v8, 1, v1
    v_lshl_add_u32 v7, v8, 1, v7
    v_bfe_u32 v8, v1, 1, 1
    v_add_u32 v7, v7, v8
    v_lshlrev_b32 v189, 13, v7
    v_lshl_add_u32 v189, v6, 4, v189
    v_xor_b32 v190, 32, v189
    s_lshl_b32 s10, s13, 21
    s_lshl_b32 s11, s3, 18
    s_add_u32 s10, s10, s11
    s_lshl_b32 s11, s6, 8
    s_add_u32 s10, s10, s11
    s_and_b32 s11, s7, 1
    s_lshl_b32 s11, s11, 7
    s_add_u32 s10, s10, s11
    s_lshl_b32 s11, s3, 12
    s_add_u32 s11, s11, 8192
    s_cmp_eq_u32 s3, 0
    s_cbranch_scc1 L_o2
    s_barrier
L_o2:
    s_cmp_lt_u32 s3, 4
    s_cbranch_scc1 L_nopk
    v_lshrrev_b32 v6, 2, v0
    v_and_b32 v7, 1, v6
    v_lshl_add_u32 v7, v1, 2, v7
    v_and_b32 v8, 3, v0
    v_lshlrev_b32 v8, 6, v8
    v_lshl_add_u32 v7, v7, 13, v8
    s_lshl_b32 s12, s7, 20
    s_lshl_b32 s8, s15, 18
    s_add_u32 s12, s12, s8
    s_lshl_b32 s8, s6, 8
    s_add_u32 s12, s12, s8
    s_add_u32 s12, s12, 8192
    v_add_u32 v7, s12, v7
    global_load_dword v254, v7, s[22:23]
    v_add_u32 v7, 8192, v7
    s_mov_b32 exec_lo, 0xf0f0f0f0
    s_mov_b32 exec_hi, 0xf0f0f0f0
    global_load_dword v254, v7, s[22:23]
    s_mov_b64 exec, -1
L_nopk:
    s_cmp_eq_u32 s3, 0
    s_cbranch_scc1 L_o3
    s_waitcnt lgkmcnt(0)
    s_add_u32 s70, s70, 1
    s_add_u32 s71, s71, 0x9e3779b9
    v_mov_b32 v12, s70
    v_mov_b32 v13, s71
L_o3:
    s_and_b32 s8, s3, 1
    s_lshl_b32 s8, s8, 3
    v_add_u32 v6, 0, v0
    v_mul_u32_u24 v7, 820, v6
    v_lshrrev_b32 v7, 16, v7
    v_lshl_add_u32 v7, v7, 1, s8
    v_xor_b32 v6, v6, v7
    v_lshlrev_b32 v170, 4, v6
    v_add_u32 v6, 64, v0
    v_mul_u32_u24 v7, 820, v6
    v_lshrrev_b32 v7, 16, v7
    v_lshl_add_u32 v7, v7, 1, s8
    v_xor_b32 v6, v6, v7
    v_lshlrev_b32 v171, 4, v6
    v_add_u32 v6, 128, v0
    v_mul_u32_u24 v7, 820, v6
    v_lshrrev_b32 v7, 16, v7
    v_lshl_add_u32 v7, v7, 1, s8
    v_xor_b32 v6, v6, v7
    v_lshlrev_b32 v172, 4, v6
    v_add_u32 v6, 192, v0
    v_mul_u32_u24 v7, 820, v6
    v_lshrrev_b32 v7, 16, v7
    v_lshl_add_u32 v7, v7, 1, s8
    v_xor_b32 v6, v6, v7
    v_lshlrev_b32 v173, 4, v6
    v_add_u32 v6, 256, v0
    v_mul_u32_u24 v7, 820, v6
    v_lshrrev_b32 v7, 16, v7
    v_lshl_add_u32 v7, v7, 1, s8
    v_xor_b32 v6, v6, v7
    v_lshlrev_b32 v174, 4, v6
    s_and_b32 s12, s7, 1
    s_lshl_b32 s8, s6, 1
    s_add_u32 s12, s12, s8
    s_mul_i32 s12, s12, 81920
    s_mul_i32 s14, s13, 40960
    s_mul_i32 s9, s3, 5120
    s_add_u32 s14, s14, s9
    s_add_u32 s12, s12, s14
    s_add_u32 s14, s14, 40960
    s_mul_i32 s9, s13, 81920
    s_sub_u32 s9, 40960, s9
    s_barrier
    s_cmp_ge_u32 s3, 4
    s_cbranch_scc1 L_nopf
    s_lshl_b32 s8, s6, 17
    s_lshl_b32 s42, s7, 15
    s_add_u32 s8, s8, s42
    s_and_b32 s42, s3, 3
    s_lshl_b32 s42, s42, 13
    s_add_u32 s8, s8, s42
    s_lshr_b32 s42, s3, 2
    s_lshl_b32 s42, s42, 12
    s_sub_u32 s8, s8, s42
    s_add_u32 s8, s8, 4096
    v_lshl_add_u32 v6, v0, 6, s8
    global_load_dword v254, v6, s[18:19]
L_nopf:
    s_mov_b32 m0, s11
    s_add_u32 s11, s11, 1024
    buffer_load_dwordx4 v189, s[52:55], s10 offen nt lds
    s_add_u32 s10, s10, 65536
    s_waitcnt vmcnt(2)
    s_mov_b32 m0, s11
    s_add_u32 s11, s11, 1024
    buffer_load_dwordx4 v189, s[52:55], s10 offen nt lds
    s_add_u32 s10, s10, 65536
    s_waitcnt vmcnt(2)
    s_mov_b32 m0, s11
    s_add_u32 s11, s11, 1024
    buffer_load_dwordx4 v190, s[52:55], s10 offen nt lds
    s_add_u32 s10, s10, 65536
    s_waitcnt vmcnt(2)
    s_mov_b32 m0, s11
    s_add_u32 s11, s11, 1024
    buffer_load_dwordx4 v190, s[52:55], s10 offen nt lds
    s_add_u32 s10, s10, 65536
    s_waitcnt vmcnt(2)
    s_mov_b32 m0, s14
    s_add_u32 s14, s14, 1024
    buffer_load_dwordx4 v170, s[56:59], s12 offen lds
    s_waitcnt vmcnt(2)
    s_mov_b32 m0, s14
    s_add_u32 s14, s14, 1024
    buffer_load_dwordx4 v171, s[56:59], s12 offen lds
    s_waitcnt vmcnt(2)
    s_mov_b32 m0, s14
    s_add_u32 s14, s14, 1024
    buffer_load_dwordx4 v172, s[56:59], s12 offen lds
    s_waitcnt vmcnt(2)
    s_mov_b32 m0, s14
    s_add_u32 s14, s14, 1024
    buffer_load_dwordx4 v173, s[56:59], s12 offen lds
    s_waitcnt vmcnt(2)
    s_mov_b32 m0, s14
    s_add_u32 s14, s14, 1024
    buffer_load_dwordx4 v174, s[56:59], s12 offen lds
    s_waitcnt vmcnt(2)
    s_add_u32 s12, s12, s9
    s_add_u32 s14, s14, s9
    s_sub_u32 s14, s14, 5120
    s_mov_b32 m0, s14
    s_add_u32 s14, s14, 1024
    buffer_load_dwordx4 v170, s[56:59], s12 offen lds
    s_mov_b32 m0, s14
    s_add_u32 s14, s14, 1024
    buffer_load_dwordx4 v171, s[56:59], s12 offen lds
    s_mov_b32 m0, s14
    s_add_u32 s14, s14, 1024
    buffer_load_dwordx4 v172, s[56:59], s12 offen lds
    s_mov_b32 m0, s14
    s_add_u32 s14, s14, 1024
    buffer_load_dwordx4 v173, s[56:59], s12 offen lds
    s_mov_b32 m0, s14
    s_add_u32 s14, s14, 1024
    buffer_load_dwordx4 v174, s[56:59], s12 offen lds
    v_lshlrev_b32 v186, 4, v0
    v_add_u32 v186, 4456448, v186
    global_load_dwordx4 v[102:105], v186, s[40:41] sc1
    s_lshr_b32 s8, s6, 4
    s_lshl_b32 s8, s8, 15
    s_and_b32 s42, s6, 15
    s_lshl_b32 s42, s42, 4
    s_add_u32 s8, s8, s42
    s_add_u32 s8, s8, 4522496
    s_lshr_b32 s42, s3, 2
    s_lshl_b32 s43, s42, 1
    v_and_b32 v6, 3, v0
    v_xor_b32 v6, s43, v6
    v_lshl_add_u32 v6, v1, 2, v6
    v_lshl_add_u32 v178, v6, 10, s8
    s_lshr_b32 s8, s6, 4
    s_lshl_b32 s8, s8, 16
    s_and_b32 s43, s4, 3
    s_lshl_b32 s43, s43, 8
    s_add_u32 s8, s8, s43
    s_lshr_b32 s43, s4, 2
    s_lshl_b32 s43, s43, 13
    s_add_u32 s8, s8, s43
    s_xor_b32 s8, s8, s38
    s_bfe_u32 s43, s6, 0x10003
    s_lshl_b32 s43, s43, 4
    s_add_u32 s8, s8, s43
    s_add_u32 s8, s8, 1310720
    v_and_b32 v7, 7, v6
    v_lshl_add_u32 v188, v7, 10, s8
    v_lshl_add_u32 v188, v4, 14, v188
    s_lshl_b32 s43, s42, 3
    v_lshlrev_b32 v187, 2, v0
    v_xor_b32 v187, s43, v187
    s_lshr_b32 s8, s6, 3
    s_lshl_b32 s8, s8, 2
    s_and_b32 s43, s6, 3
    s_add_u32 s8, s8, s43
    s_lshl_b32 s8, s8, 17
    s_lshr_b32 s43, s4, 2
    s_lshl_b32 s43, s43, 13
    s_add_u32 s8, s8, s43
    s_xor_b32 s8, s8, s38
    s_xor_b32 s8, s8, 0x2000
    s_lshl_b32 s43, s13, 10
    s_add_u32 s8, s8, s43
    s_lshl_b32 s43, s15, 7
    s_add_u32 s8, s8, s43
    s_lshl_b32 s43, s42, 12
    s_add_u32 s8, s8, s43
    s_add_u32 s8, s8, 2097664
    v_lshl_add_u32 v179, v1, 14, s8
    v_lshl_add_u32 v179, v2, 4, v179
    s_lshl_b32 s8, s15, 9
    s_add_u32 s8, s8, 4096
    s_lshl_b32 s43, s42, 8
    s_add_u32 s43, s43, s8
    v_lshrrev_b32 v8, 1, v4
    v_lshl_add_u32 v180, v8, 7, s43
    v_lshl_add_u32 v180, v2, 4, v180
    v_lshlrev_b32 v6, 9, v8
    v_and_b32 v8, 1, v4
    v_lshl_add_u32 v180, v8, 3, v180
    v_lshl_add_u32 v6, v8, 7, v6
    v_and_b32 v8, 3, v0
    v_lshl_add_u32 v181, v8, 7, s8
    v_lshl_add_u32 v181, v4, 4, v181
    s_lshl_b32 s8, s15, 2
    v_add_u32 v8, s8, v8
    v_lshrrev_b32 v7, 1, v8
    s_lshl_b32 s8, s42, 2
    v_xor_b32 v7, s8, v7
    v_xor_b32 v7, v7, v4
    v_lshlrev_b32 v182, 7, v8
    v_lshl_add_u32 v182, v7, 4, v182
    v_lshrrev_b32 v7, 1, v3
    v_xor_b32 v7, v7, v4
    v_lshlrev_b32 v184, 7, v3
    v_lshl_add_u32 v184, v7, 4, v184
    v_xor_b32 v176, 64, v184
    s_lshl_b32 s64, s42, 1
    s_lshr_b32 s8, s2, 2
    s_lshl_b32 s8, s8, 14
    s_and_b32 s42, s2, 3
    s_lshl_b32 s42, s42, 11
    s_add_u32 s8, s8, s42
    s_and_b32 s42, s3, 3
    s_lshl_b32 s42, s42, 9
    s_add_u32 s8, s8, s42
    s_lshr_b32 s42, s3, 2
    s_lshl_b32 s42, s42, 13
    s_add_u32 s8, s8, s42
    s_xor_b32 s8, s8, s38
    s_add_u32 s8, s8, 524288
    v_lshl_add_u32 v183, v0, 2, s8
    v_bfe_u32 v146, v0, 2, 2
    v_lshl_add_u32 v6, v146, 11, v6
    v_and_b32 v8, 3, v0
    v_lshl_add_u32 v6, v8, 3, v6
    s_lshl_b32 s8, s15, 13
    s_add_u32 s8, s8, 8192
    v_add_u32 v6, s8, v6
    v_xor_b32 v146, s64, v146
    v_xor_b32 v8, 0, v146
    v_lshl_add_u32 v162, v8, 5, v6
    v_xor_b32 v8, 1, v146
    v_lshl_add_u32 v163, v8, 5, v6
    v_lshrrev_b32 v7, 2, v0
    v_and_b32 v9, 7, v7
    v_and_b32 v8, 3, v0
    v_mul_u32_u24 v7, 1280, v7
    v_lshl_add_u32 v7, v8, 3, v7
    v_add_u32 v7, 40960, v7
    s_mul_i32 s13, s3, 5
    v_xor_b32 v170, s13, v9
    v_lshl_add_u32 v170, v170, 5, v7
    s_add_u32 s13, s13, 1
    v_xor_b32 v171, s13, v9
    v_lshl_add_u32 v171, v171, 5, v7
    s_add_u32 s13, s13, 1
    v_xor_b32 v172, s13, v9
    v_lshl_add_u32 v172, v172, 5, v7
    s_add_u32 s13, s13, 1
    v_xor_b32 v173, s13, v9
    v_lshl_add_u32 v173, v173, 5, v7
    s_add_u32 s13, s13, 1
    v_xor_b32 v174, s13, v9
    v_lshl_add_u32 v174, v174, 5, v7
    s_add_u32 s13, s13, 1
    s_mov_b32 s26, 0xffff0000
    s_mov_b32 s27, 0xffff0000
    s_mov_b32 s28, 0
    s_mov_b32 s29, -1
    s_lshl_b32 s8, s2, 8
    s_add_u32 s8, s8, 4489216
    s_waitcnt vmcnt(0)
    s_mov_b32 s13, 0
    s_branch L_voc
L_vop:
    global_load_dwordx4 v[102:105], v186, s[40:41] sc1
    s_waitcnt vmcnt(0)
L_voc:
    s_add_u32 s13, s13, 1
    v_cmp_eq_u32 s[72:73], 1, v102
    v_cmp_ne_u64 vcc, s[70:71], v[104:105]
    s_cmp_gt_u32 s13, 200000
    s_cbranch_scc1 L_voo
    s_cbranch_vccnz L_vop
L_voo:
    s_bcnt1_i32_b64 s38, s[72:73]
    s_cmp_gt_u32 s38, 32
    s_cselect_b32 s38, 0x2000, 0
    v_xor_b32 v179, s38, v179
    v_xor_b32 v183, s38, v183
    v_xor_b32 v188, s38, v188
    s_lshr_b32 s8, s2, 5
    s_lshl_b32 s8, s8, 14
    s_and_b32 s43, s2, 31
    s_lshl_b32 s43, s43, 8
    s_add_u32 s8, s8, s43
    s_add_u32 s8, s8, 4194304
    v_lshl_add_u32 v185, v2, 4, s8
    v_and_b32 v6, 3, v1
    v_lshl_add_u32 v185, v6, 16, v185
    v_lshrrev_b32 v6, 5, v0
    v_lshl_add_u32 v185, v6, 13, v185
    s_cmp_eq_u32 s3, 7
    s_cselect_b64 s[44:45], -1, 0
    s_cmp_eq_u32 s3, 0
    s_cselect_b64 s[42:43], -1, 0
    s_cbranch_scc0 L_gow
    s_mov_b32 s13, 0
    s_mov_b64 vcc, -1
    s_waitcnt vmcnt(0)
L_gop:
    s_mov_b64 exec, vcc
    global_load_dwordx4 v[150:153], v188, s[40:41] sc1
    s_mov_b64 exec, -1
    s_add_u32 s13, s13, 1
    s_waitcnt vmcnt(0)
    v_cmp_ne_u64 vcc, s[70:71], v[152:153]
    s_cmp_gt_u32 s13, 200000
    s_cbranch_scc1 L_goo
    s_cbranch_vccnz L_gop
L_goo:
    ds_write_b32 v187, v150 offset:0
L_gow:
    s_waitcnt vmcnt(0)
L_gox:
    s_waitcnt lgkmcnt(0)
    s_barrier
    global_load_dwordx4 v[102:105], v179, s[40:41] offset:0 sc1
    global_load_dwordx4 v[106:109], v179, s[40:41] offset:2048 sc1
    ds_read_b32 v9, v187 offset:0
    s_mov_b64 exec, s[44:45]
    global_load_dwordx4 v[150:153], v178, s[40:41] offset:256 sc1
    s_mov_b64 exec, -1
    s_waitcnt lgkmcnt(0)
    v_max_f32_dpp v6, v9, v9 quad_perm:[1,0,3,2] row_mask:0xf bank_mask:0xf
    s_nop 1
    v_max_f32_dpp v6, v6, v6 quad_perm:[2,3,0,1] row_mask:0xf bank_mask:0xf
    s_nop 1
    v_max_f32_dpp v6, v6, v6 row_ror:8 row_mask:0xf bank_mask:0xf
    v_mov_b32 v7, v6
    s_nop 1
    v_permlane16_swap_b32 v6, v7
    v_max_f32 v6, v6, v7
    v_mov_b32 v7, v6
    s_nop 1
    v_permlane32_swap_b32 v6, v7
    v_max_f32 v6, v6, v7
    v_sub_f32 v9, v9, v6
    v_exp_f32 v9, v9
    s_mov_b32 s13, 0
    v_cvt_pk_bf16_f32 v8, v9, v9
    s_nop 1
    v_and_b32_dpp v94, v8, v14 quad_perm:[0,0,0,0] row_mask:0xf bank_mask:0xf
    v_and_b32_dpp v95, v8, v15 quad_perm:[0,0,0,0] row_mask:0xf bank_mask:0xf
    v_and_b32_dpp v96, v8, v16 quad_perm:[0,0,0,0] row_mask:0xf bank_mask:0xf
    v_and_b32_dpp v97, v8, v17 quad_perm:[0,0,0,0] row_mask:0xf bank_mask:0xf
    v_and_b32_dpp v98, v8, v14 quad_perm:[1,1,1,1] row_mask:0xf bank_mask:0xf
    v_and_b32_dpp v99, v8, v15 quad_perm:[1,1,1,1] row_mask:0xf bank_mask:0xf
    v_and_b32_dpp v100, v8, v16 quad_perm:[1,1,1,1] row_mask:0xf bank_mask:0xf
    v_and_b32_dpp v101, v8, v17 quad_perm:[1,1,1,1] row_mask:0xf bank_mask:0xf
    ds_read_b64_tr_b16 v[62:63], v162 offset:0
    ds_read_b64_tr_b16 v[64:65], v162 offset:256
    ds_read_b64_tr_b16 v[66:67], v163 offset:0
    ds_read_b64_tr_b16 v[68:69], v163 offset:256
    s_waitcnt lgkmcnt(5)
    ds_read_b64_tr_b16 v[70:71], v162 offset:1024
    ds_read_b64_tr_b16 v[72:73], v162 offset:1280
    ds_read_b64_tr_b16 v[74:75], v163 offset:1024
    ds_read_b64_tr_b16 v[76:77], v163 offset:1280
    s_waitcnt lgkmcnt(5)
    ds_read_b64_tr_b16 v[22:23], v170 offset:0
    ds_read_b64_tr_b16 v[24:25], v170 offset:20480
    ds_read_b64_tr_b16 v[26:27], v170 offset:40960
    ds_read_b64_tr_b16 v[28:29], v170 offset:61440
    ds_read_b64_tr_b16 v[30:31], v171 offset:0
    ds_read_b64_tr_b16 v[32:33], v171 offset:20480
    ds_read_b64_tr_b16 v[34:35], v171 offset:40960
    ds_read_b64_tr_b16 v[36:37], v171 offset:61440
    s_waitcnt lgkmcnt(5)
    ds_read_b64_tr_b16 v[38:39], v172 offset:0
    ds_read_b64_tr_b16 v[40:41], v172 offset:20480
    ds_read_b64_tr_b16 v[42:43], v172 offset:40960
    ds_read_b64_tr_b16 v[44:45], v172 offset:61440
    ds_read_b64_tr_b16 v[46:47], v173 offset:0
    ds_read_b64_tr_b16 v[48:49], v173 offset:20480
    ds_read_b64_tr_b16 v[50:51], v173 offset:40960
    ds_read_b64_tr_b16 v[52:53], v173 offset:61440
    s_waitcnt lgkmcnt(5)
    ds_read_b64_tr_b16 v[54:55], v174 offset:0
    ds_read_b64_tr_b16 v[56:57], v174 offset:20480
    ds_read_b64_tr_b16 v[58:59], v174 offset:40960
    ds_read_b64_tr_b16 v[60:61], v174 offset:61440
    s_waitcnt vmcnt(1)
    s_branch L_pbc
L_pbp:
    s_mov_b64 exec, s[72:73]
    global_load_dwordx4 v[102:105], v179, s[40:41] offset:0 sc1
    s_mov_b64 exec, s[74:75]
    global_load_dwordx4 v[106:109], v179, s[40:41] offset:2048 sc1
    s_mov_b64 exec, -1
    s_waitcnt vmcnt(0)
L_pbc:
    s_add_u32 s13, s13, 1
    v_mfma_f32_16x16x32_bf16 v[18:21], v[94:97], v[102:105], 0
    v_max3_u32 v8, v102, v103, v104
    v_max_u32 v8, v8, v105
    v_cmp_eq_u32 s[72:73], -1, v8
    v_mfma_f32_16x16x32_bf16 v[18:21], v[98:101], v[106:109], v[18:21]
    v_max3_u32 v8, v106, v107, v108
    v_max_u32 v8, v8, v109
    v_cmp_eq_u32 s[74:75], -1, v8
    s_nop 0
    s_or_b64 vcc, s[72:73], s[74:75]
    s_cmp_gt_u32 s13, 200000
    s_cbranch_scc1 L_pbo
    s_cbranch_vccnz L_pbp
L_pbo:
    v_cvt_pk_bf16_f32 v154, v18, v19
    v_cvt_pk_bf16_f32 v155, v20, v21
    s_mov_b32 exec_lo, 0xff00ff
    s_mov_b32 exec_hi, 0xff00ff00
    ds_write_b64 v180, v[154:155]
    s_mov_b64 exec, -1
    s_waitcnt lgkmcnt(0)
    s_barrier
    ds_read_b128 v[162:165], v181
    ds_read_b128 v[166:169], v181 offset:64
    v_mov_b32 v8, 1024
    s_cmp_lg_u32 s3, 7
    s_cbranch_scc1 L_nolr
    s_mov_b32 s13, 0
    s_waitcnt vmcnt(0)
    s_branch L_lrc
L_lrp:
    s_mov_b64 exec, vcc
    global_load_dwordx4 v[150:153], v178, s[40:41] offset:256 sc1
    s_mov_b64 exec, -1
    s_waitcnt vmcnt(0)
L_lrc:
    s_add_u32 s13, s13, 1
    v_cmp_ne_u64 vcc, s[70:71], v[152:153]
    s_cmp_gt_u32 s13, 200000
    s_cbranch_scc1 L_lro
    s_cbranch_vccnz L_lrp
L_lro:
    v_mul_f32 v9, v9, v150
    s_nop 1
    v_add_f32_dpp v6, v9, v9 quad_perm:[1,0,3,2] row_mask:0xf bank_mask:0xf
    s_nop 1
    v_add_f32_dpp v6, v6, v6 quad_perm:[2,3,0,1] row_mask:0xf bank_mask:0xf
    s_nop 1
    v_add_f32_dpp v6, v6, v6 row_ror:8 row_mask:0xf bank_mask:0xf
    v_mov_b32 v7, v6
    s_nop 1
    v_permlane16_swap_b32 v6, v7
    v_add_f32 v6, v6, v7
    v_mov_b32 v7, v6
    s_nop 1
    v_permlane32_swap_b32 v6, v7
    v_add_f32 v6, v6, v7
    v_rcp_f32 v6, v6
    s_waitcnt lgkmcnt(0)
    ds_write_b32 v8, v6
L_nolr:
    s_waitcnt lgkmcnt(1)
    v_mfma_f32_16x16x32_bf16 v[130:133], v[62:65], v[162:165], 0
    v_mfma_f32_16x16x32_bf16 v[134:137], v[66:69], v[162:165], 0
    s_waitcnt lgkmcnt(0)
    v_mfma_f32_16x16x32_bf16 v[130:133], v[70:73], v[166:169], v[130:133]
    v_mfma_f32_16x16x32_bf16 v[134:137], v[74:77], v[166:169], v[134:137]
    s_nop 6
    v_cvt_pk_bf16_f32 v154, v130, v131
    v_cvt_pk_bf16_f32 v155, v132, v133
    v_cvt_pk_bf16_f32 v156, v134, v135
    v_cvt_pk_bf16_f32 v157, v136, v137
    s_mov_b32 exec_lo, 0xf000f
    s_mov_b32 exec_hi, 0xf000f
    ds_write_b128 v182, v[154:157] offset:2048
    s_mov_b64 exec, -1
    s_mov_b64 exec, s[42:43]
    global_store_dwordx4 v185, v[10:13], s[40:41] sc1
    s_mov_b64 exec, -1
    s_waitcnt lgkmcnt(0)
    s_barrier
    ds_read_b128 v[154:157], v184 offset:2048
    ds_read_b128 v[158:161], v176 offset:2048
    ds_read_b32 v186, v8
    s_waitcnt lgkmcnt(2)
    v_mfma_f32_16x16x32_bf16 v[126:129], v[154:157], v[54:57], 0
    v_mfma_f32_16x16x32_bf16 v[110:113], v[154:157], v[22:25], 0
    v_mfma_f32_16x16x32_bf16 v[118:121], v[154:157], v[38:41], 0
    v_mfma_f32_16x16x32_bf16 v[114:117], v[154:157], v[30:33], 0
    v_mfma_f32_16x16x32_bf16 v[122:125], v[154:157], v[46:49], 0
    s_waitcnt lgkmcnt(1)
    v_mfma_f32_16x16x32_bf16 v[126:129], v[158:161], v[58:61], v[126:129]
    v_mfma_f32_16x16x32_bf16 v[110:113], v[158:161], v[26:29], v[110:113]
    v_mfma_f32_16x16x32_bf16 v[118:121], v[158:161], v[42:45], v[118:121]
    v_mfma_f32_16x16x32_bf16 v[114:117], v[158:161], v[34:37], v[114:117]
    v_mfma_f32_16x16x32_bf16 v[122:125], v[158:161], v[50:53], v[122:125]
    s_nop 3
    v_pk_add_f32 v[126:127], v[126:127], v[128:129]
    v_pk_add_f32 v[110:111], v[110:111], v[112:113]
    v_pk_add_f32 v[118:119], v[118:119], v[120:121]
    v_pk_add_f32 v[114:115], v[114:115], v[116:117]
    v_pk_add_f32 v[122:123], v[122:123], v[124:125]
    v_add_f32 v126, v126, v127
    v_add_f32 v110, v110, v111
    v_add_f32 v118, v118, v119
    v_add_f32 v114, v114, v115
    v_add_f32 v122, v122, v123
    v_mov_b32 v127, v126
    v_permlane32_swap_b32 v110, v118
    v_permlane32_swap_b32 v114, v122
    v_permlane32_swap_b32 v126, v127
    v_add_f32 v110, v110, v118
    v_add_f32 v114, v114, v122
    v_add_f32 v126, v126, v127
    s_waitcnt lgkmcnt(0)
    v_mov_b32 v127, v126
    v_permlane16_swap_b32 v110, v114
    v_add_f32 v110, v110, v114
    v_permlane16_swap_b32 v126, v127
    v_mul_f32 v110, v186, v110
    v_add_f32 v126, v126, v127
    global_store_dword v183, v110, s[40:41] sc1
    v_mul_f32 v126, v186, v126
    s_mov_b32 exec_hi, 0
    global_store_dword v183, v126, s[40:41] offset:256 sc1
    s_mov_b32 exec_hi, -1
    s_branch L_fin
L_roleA:
    s_lshl_b32 s8, s79, 17
    s_lshl_b32 s9, s3, 14
    s_add_u32 s8, s8, s9
    s_lshl_b32 s10, s78, 13
    v_lshlrev_b32 v9, 4, v0
    v_xor_b32 v214, 0, v9
    v_xor_b32 v215, 32, v9
    v_xor_b32 v216, 64, v9
    v_xor_b32 v217, 96, v9
    v_xor_b32 v218, 128, v9
    v_xor_b32 v219, 160, v9
    v_xor_b32 v220, 192, v9
    v_xor_b32 v221, 224, v9
    s_mov_b32 s48, s18
    s_mov_b32 s49, s19
    s_mov_b32 s50, 4194304
    s_mov_b32 s51, 0x20000
    s_cmp_eq_u32 s3, 0
    s_cbranch_scc1 L_a1
    s_barrier
L_a1:
    s_add_u32 s11, s9, s10
    s_add_u32 s14, s8, s10
    s_mov_b32 m0, s11
    s_add_u32 s10, s10, 4096
    s_and_b32 s10, s10, 0x3fff
    buffer_load_dwordx4 v214, s[48:51], s14 offen offset:0 lds
    buffer_load_dwordx4 v215, s[48:51], s14 offen offset:1024 lds
    buffer_load_dwordx4 v216, s[48:51], s14 offen offset:2048 lds
    buffer_load_dwordx4 v217, s[48:51], s14 offen offset:3072 lds
    s_cmp_eq_u32 s3, 0
    s_cbranch_scc1 L_a2
    s_waitcnt lgkmcnt(0)
    s_add_u32 s70, s70, 1
    s_add_u32 s71, s71, 0x9e3779b9
    v_mov_b32 v12, s70
    v_mov_b32 v13, s71
L_a2:
    s_barrier
    s_add_u32 s11, s9, s10
    s_add_u32 s14, s8, s10
    s_mov_b32 m0, s11
    s_add_u32 s10, s10, 4096
    s_and_b32 s10, s10, 0x3fff
    buffer_load_dwordx4 v218, s[48:51], s14 offen offset:0 lds
    buffer_load_dwordx4 v219, s[48:51], s14 offen offset:1024 lds
    buffer_load_dwordx4 v220, s[48:51], s14 offen offset:2048 lds
    buffer_load_dwordx4 v221, s[48:51], s14 offen offset:3072 lds
    s_lshl_b32 s12, s78, 3
    s_add_u32 s12, s12, s3
    s_lshl_b32 s12, s12, 17
    s_lshr_b32 s13, s79, 2
    s_lshl_b32 s13, s13, 14
    s_add_u32 s12, s12, s13
    s_and_b32 s13, s79, 3
    s_lshl_b32 s13, s13, 11
    s_add_u32 s12, s12, s13
    s_add_u32 s12, s12, 2097664
    v_lshl_add_u32 v6, v0, 4, s12
    v_lshrrev_b32 v7, 5, v0
    v_lshl_add_u32 v6, v7, 9, v6
    v_add_u32 v7, 0x2000, v6
    global_store_dwordx4 v6, v[18:21], s[40:41] sc1
    global_store_dwordx4 v7, v[18:21], s[40:41] sc1
    s_add_u32 s11, s9, s10
    s_add_u32 s14, s8, s10
    s_mov_b32 m0, s11
    s_add_u32 s10, s10, 4096
    s_and_b32 s10, s10, 0x3fff
    buffer_load_dwordx4 v214, s[48:51], s14 offen offset:0 lds
    buffer_load_dwordx4 v215, s[48:51], s14 offen offset:1024 lds
    buffer_load_dwordx4 v216, s[48:51], s14 offen offset:2048 lds
    buffer_load_dwordx4 v217, s[48:51], s14 offen offset:3072 lds
    s_add_u32 s11, s9, s10
    s_add_u32 s14, s8, s10
    s_mov_b32 m0, s11
    s_add_u32 s10, s10, 4096
    s_and_b32 s10, s10, 0x3fff
    buffer_load_dwordx4 v218, s[48:51], s14 offen offset:0 lds
    buffer_load_dwordx4 v219, s[48:51], s14 offen offset:1024 lds
    buffer_load_dwordx4 v220, s[48:51], s14 offen offset:2048 lds
    buffer_load_dwordx4 v221, s[48:51], s14 offen offset:3072 lds
    v_lshlrev_b32 v5, 4, v0
    v_add_u32 v5, 4456448, v5
    global_load_dwordx4 v[238:241], v5, s[40:41] sc1
    v_lshl_add_u32 v6, v3, 10, s9
    v_lshlrev_b32 v7, 1, v2
    v_xor_b32 v7, v7, v4
    v_xor_b32 v8, 0, v7
    v_lshl_add_u32 v214, v8, 4, v6
    v_xor_b32 v8, 4, v7
    v_lshl_add_u32 v215, v8, 4, v6
    v_xor_b32 v8, 8, v7
    v_lshl_add_u32 v216, v8, 4, v6
    v_xor_b32 v8, 12, v7
    v_lshl_add_u32 v217, v8, 4, v6
    v_xor_b32 v6, v3, v4
    v_lshlrev_b32 v7, 8, v4
    v_lshl_add_u32 v230, v6, 4, v7
    v_add_u32 v230, 131072, v230
    v_xor_b32 v231, 64, v230
    s_lshl_b32 s12, s78, 20
    s_lshr_b32 s13, s79, 2
    s_lshl_b32 s13, s13, 14
    s_add_u32 s12, s12, s13
    s_and_b32 s13, s79, 3
    s_lshl_b32 s13, s13, 11
    s_add_u32 s12, s12, s13
    s_lshl_b32 s13, s15, 7
    s_add_u32 s12, s12, s13
    s_lshr_b32 s13, s3, 2
    s_lshl_b32 s13, s13, 10
    s_add_u32 s12, s12, s13
    s_add_u32 s12, s12, 2097664
    v_lshrrev_b32 v6, 1, v4
    v_lshl_add_u32 v222, v6, 19, s12
    v_and_b32 v6, 1, v4
    v_lshl_add_u32 v222, v6, 13, v222
    s_xor_b32 s13, s38, 0x2000
    v_xor_b32 v222, s13, v222
    v_lshl_add_u32 v222, v3, 3, v222
    v_add_u32 v223, 0x20000, v222
    v_add_u32 v224, 0x40000, v222
    v_add_u32 v225, 0x60000, v222
    v_lshlrev_b32 v232, 4, v0
    v_add_u32 v232, 147456, v232
    s_lshr_b32 s8, s3, 1
    s_lshl_b32 s8, s8, 10
    s_and_b32 s13, s3, 1
    s_lshl_b32 s13, s13, 3
    s_add_u32 s8, s8, s13
    v_add_u32 v233, s8, v232
    v_lshlrev_b32 v235, 5, v3
    v_add_u32 v235, 151552, v235
    s_lshl_b32 s8, s3, 2
    v_add_u32 v234, s8, v235
    s_lshl_b32 s10, s78, 15
    s_lshl_b32 s8, s79, 10
    s_add_u32 s10, s10, s8
    s_add_u32 s10, s10, 4522496
    v_lshl_add_u32 v226, v3, 4, s10
    s_lshl_b32 s10, s78, 16
    s_lshr_b32 s8, s79, 3
    s_lshl_b32 s8, s8, 14
    s_add_u32 s10, s10, s8
    s_lshl_b32 s8, s4, 10
    s_add_u32 s10, s10, s8
    s_add_u32 s10, s10, 1310720
    v_and_b32 v6, 3, v0
    v_lshl_add_u32 v236, v6, 8, s10
    v_bfe_u32 v6, v0, 2, 1
    v_lshl_add_u32 v236, v6, 13, v236
    v_xor_b32 v236, s38, v236
    v_lshl_add_u32 v236, v1, 4, v236
    s_lshl_b32 s11, s78, 16
    s_lshr_b32 s12, s3, 1
    s_lshl_b32 s12, s12, 14
    s_add_u32 s11, s11, s12
    s_and_b32 s12, s3, 1
    s_lshl_b32 s12, s12, 12
    s_add_u32 s11, s11, s12
    s_and_b32 s12, s4, 3
    s_lshl_b32 s12, s12, 17
    s_add_u32 s11, s11, s12
    s_lshr_b32 s12, s4, 2
    s_lshl_b32 s12, s12, 13
    s_add_u32 s11, s11, s12
    s_xor_b32 s11, s11, s38
    s_add_u32 s11, s11, 1573376
    v_lshl_add_u32 v227, v0, 4, s11
    v_lshrrev_b32 v6, 5, v0
    v_lshl_add_u32 v227, v6, 9, v227
    s_lshl_b32 s8, s3, 1
    v_xor_b32 v6, s8, v2
    v_lshlrev_b32 v7, 8, v0
    v_lshl_add_u32 v228, v6, 4, v7
    v_add_u32 v228, 131072, v228
    v_xor_b32 v229, 16, v228
    s_cmp_eq_u32 s3, 3
    s_cselect_b64 s[42:43], -1, 0
    s_waitcnt vmcnt(0) lgkmcnt(0)
    ds_read_b128 v[22:25], v214 offset:0
    ds_read_b128 v[26:29], v215 offset:0
    ds_read_b128 v[30:33], v216 offset:0
    ds_read_b128 v[34:37], v217 offset:0
    ds_read_b128 v[38:41], v214 offset:256
    ds_read_b128 v[42:45], v215 offset:256
    ds_read_b128 v[46:49], v216 offset:256
    ds_read_b128 v[50:53], v217 offset:256
    ds_read_b128 v[54:57], v214 offset:512
    ds_read_b128 v[58:61], v215 offset:512
    ds_read_b128 v[62:65], v216 offset:512
    ds_read_b128 v[66:69], v217 offset:512
    s_waitcnt lgkmcnt(6)
    ds_read_b128 v[70:73], v214 offset:768
    ds_read_b128 v[74:77], v215 offset:768
    ds_read_b128 v[78:81], v216 offset:768
    ds_read_b128 v[82:85], v217 offset:768
    s_mov_b32 s13, 0
    s_branch L_vac
L_vap:
    global_load_dwordx4 v[238:241], v5, s[40:41] sc1
    s_waitcnt vmcnt(0)
L_vac:
    s_add_u32 s13, s13, 1
    v_cmp_eq_u32 s[72:73], 1, v238
    v_cmp_ne_u64 vcc, s[70:71], v[240:241]
    s_cmp_gt_u32 s13, 200000
    s_cbranch_scc1 L_vao
    s_cbranch_vccnz L_vap
L_vao:
    s_bcnt1_i32_b64 s38, s[72:73]
    s_cmp_gt_u32 s38, 32
    s_cselect_b32 s38, 0x2000, 0
    v_xor_b32 v227, s38, v227
    v_xor_b32 v236, s38, v236
    v_xor_b32 v222, s38, v222
    v_xor_b32 v223, s38, v223
    v_xor_b32 v224, s38, v224
    v_xor_b32 v225, s38, v225
    v_lshrrev_b32 v6, 2, v0
    v_and_b32 v7, 7, v6
    v_lshlrev_b32 v6, 10, v6
    v_and_b32 v8, 3, v0
    v_lshl_add_u32 v6, v8, 3, v6
    s_lshr_b32 s8, s3, 1
    s_lshl_b32 s8, s8, 8
    v_add_u32 v6, s8, v6
    s_and_b32 s8, s3, 1
    s_lshl_b32 s8, s8, 2
    v_xor_b32 v7, s8, v7
    v_xor_b32 v8, 0, v7
    v_lshl_add_u32 v214, v8, 5, v6
    v_add_u32 v218, 0x10000, v214
    v_xor_b32 v8, 1, v7
    v_lshl_add_u32 v215, v8, 5, v6
    v_add_u32 v219, 0x10000, v215
    v_xor_b32 v8, 2, v7
    v_lshl_add_u32 v216, v8, 5, v6
    v_add_u32 v220, 0x10000, v216
    v_xor_b32 v8, 3, v7
    v_lshl_add_u32 v217, v8, 5, v6
    v_add_u32 v221, 0x10000, v217
    s_barrier
    global_load_dwordx4 v[238:241], v227, s[40:41] offset:0 sc1
    global_load_dwordx4 v[242:245], v227, s[40:41] offset:2048 sc1
    s_waitcnt lgkmcnt(4)
    ds_read_b64_tr_b16 v[86:87], v214 offset:0
    ds_read_b64_tr_b16 v[88:89], v214 offset:16384
    ds_read_b64_tr_b16 v[90:91], v214 offset:32768
    ds_read_b64_tr_b16 v[92:93], v214 offset:49152
    ds_read_b64_tr_b16 v[94:95], v218 offset:0
    ds_read_b64_tr_b16 v[96:97], v218 offset:16384
    ds_read_b64_tr_b16 v[98:99], v218 offset:32768
    ds_read_b64_tr_b16 v[100:101], v218 offset:49152
    s_waitcnt lgkmcnt(4)
    ds_read_b64_tr_b16 v[102:103], v215 offset:0
    ds_read_b64_tr_b16 v[104:105], v215 offset:16384
    ds_read_b64_tr_b16 v[106:107], v215 offset:32768
    ds_read_b64_tr_b16 v[108:109], v215 offset:49152
    ds_read_b64_tr_b16 v[110:111], v219 offset:0
    ds_read_b64_tr_b16 v[112:113], v219 offset:16384
    ds_read_b64_tr_b16 v[114:115], v219 offset:32768
    ds_read_b64_tr_b16 v[116:117], v219 offset:49152
    s_waitcnt lgkmcnt(4)
    ds_read_b64_tr_b16 v[118:119], v216 offset:0
    ds_read_b64_tr_b16 v[120:121], v216 offset:16384
    ds_read_b64_tr_b16 v[122:123], v216 offset:32768
    ds_read_b64_tr_b16 v[124:125], v216 offset:49152
    ds_read_b64_tr_b16 v[126:127], v220 offset:0
    ds_read_b64_tr_b16 v[128:129], v220 offset:16384
    ds_read_b64_tr_b16 v[130:131], v220 offset:32768
    ds_read_b64_tr_b16 v[132:133], v220 offset:49152
    s_waitcnt lgkmcnt(4)
    ds_read_b64_tr_b16 v[134:135], v217 offset:0
    ds_read_b64_tr_b16 v[136:137], v217 offset:16384
    ds_read_b64_tr_b16 v[138:139], v217 offset:32768
    ds_read_b64_tr_b16 v[140:141], v217 offset:49152
    ds_read_b64_tr_b16 v[142:143], v221 offset:0
    ds_read_b64_tr_b16 v[144:145], v221 offset:16384
    ds_read_b64_tr_b16 v[146:147], v221 offset:32768
    ds_read_b64_tr_b16 v[148:149], v221 offset:49152
    s_mov_b32 s13, 0
    s_branch L_qac
L_qap:
    s_mov_b64 exec, s[72:73]
    global_load_dwordx4 v[238:241], v227, s[40:41] offset:0 sc1
    s_mov_b64 exec, s[74:75]
    global_load_dwordx4 v[242:245], v227, s[40:41] offset:2048 sc1
    s_mov_b64 exec, -1
L_qac:
    s_add_u32 s13, s13, 1
    s_waitcnt vmcnt(1)
    ds_write_b128 v228, v[238:241]
    v_max3_u32 v8, v238, v239, v240
    v_max_u32 v8, v8, v241
    v_cmp_eq_u32 s[72:73], -1, v8
    s_waitcnt vmcnt(0)
    ds_write_b128 v229, v[242:245]
    v_max3_u32 v8, v242, v243, v244
    v_max_u32 v8, v8, v245
    v_cmp_eq_u32 s[74:75], -1, v8
    s_nop 0
    s_or_b64 vcc, s[72:73], s[74:75]
    s_cmp_gt_u32 s13, 200000
    s_cbranch_scc1 L_qao
    s_cbranch_vccnz L_qap
L_qao:
    s_waitcnt lgkmcnt(0)
    s_barrier
    ds_read_b128 v[150:153], v230 offset:0
    ds_read_b128 v[154:157], v231 offset:1024
    ds_read_b128 v[158:161], v230 offset:2048
    ds_read_b128 v[162:165], v231 offset:3072
    ds_read_b128 v[166:169], v230 offset:4096
    ds_read_b128 v[170:173], v231 offset:5120
    ds_read_b128 v[174:177], v230 offset:6144
    ds_read_b128 v[178:181], v231 offset:7168
    ds_read_b128 v[182:185], v230 offset:8192
    ds_read_b128 v[186:189], v231 offset:9216
    ds_read_b128 v[190:193], v230 offset:10240
    ds_read_b128 v[194:197], v231 offset:11264
    s_waitcnt lgkmcnt(11)
    v_mfma_f32_16x16x32_bf16 v[18:21], v[22:25], v[150:153], 0
    ds_read_b128 v[198:201], v230 offset:12288
    s_waitcnt lgkmcnt(11)
    v_mfma_f32_16x16x32_bf16 v[18:21], v[26:29], v[154:157], v[18:21]
    ds_read_b128 v[202:205], v231 offset:13312
    s_waitcnt lgkmcnt(11)
    v_mfma_f32_16x16x32_bf16 v[18:21], v[30:33], v[158:161], v[18:21]
    ds_read_b128 v[206:209], v230 offset:14336
    s_waitcnt lgkmcnt(11)
    v_mfma_f32_16x16x32_bf16 v[18:21], v[34:37], v[162:165], v[18:21]
    ds_read_b128 v[210:213], v231 offset:15360
    s_waitcnt lgkmcnt(11)
    v_mfma_f32_16x16x32_bf16 v[18:21], v[38:41], v[166:169], v[18:21]
    s_waitcnt lgkmcnt(10)
    v_mfma_f32_16x16x32_bf16 v[18:21], v[42:45], v[170:173], v[18:21]
    s_waitcnt lgkmcnt(9)
    v_mfma_f32_16x16x32_bf16 v[18:21], v[46:49], v[174:177], v[18:21]
    s_waitcnt lgkmcnt(8)
    v_mfma_f32_16x16x32_bf16 v[18:21], v[50:53], v[178:181], v[18:21]
    s_waitcnt lgkmcnt(7)
    v_mfma_f32_16x16x32_bf16 v[18:21], v[54:57], v[182:185], v[18:21]
    s_waitcnt lgkmcnt(6)
    v_mfma_f32_16x16x32_bf16 v[18:21], v[58:61], v[186:189], v[18:21]
    s_waitcnt lgkmcnt(5)
    v_mfma_f32_16x16x32_bf16 v[18:21], v[62:65], v[190:193], v[18:21]
    s_waitcnt lgkmcnt(4)
    v_mfma_f32_16x16x32_bf16 v[18:21], v[66:69], v[194:197], v[18:21]
    s_waitcnt lgkmcnt(3)
    v_mfma_f32_16x16x32_bf16 v[18:21], v[70:73], v[198:201], v[18:21]
    s_waitcnt lgkmcnt(2)
    v_mfma_f32_16x16x32_bf16 v[18:21], v[74:77], v[202:205], v[18:21]
    s_waitcnt lgkmcnt(1)
    v_mfma_f32_16x16x32_bf16 v[18:21], v[78:81], v[206:209], v[18:21]
    s_waitcnt lgkmcnt(0)
    v_mfma_f32_16x16x32_bf16 v[18:21], v[82:85], v[210:213], v[18:21]
    s_nop 7
    v_max3_f32 v6, v18, v19, v20
    v_max_f32 v6, v6, v21
    v_mov_b32 v7, v6
    s_nop 1
    v_permlane16_swap_b32 v6, v7
    v_max_f32 v6, v6, v7
    v_mov_b32 v7, v6
    s_nop 1
    v_permlane32_swap_b32 v6, v7
    v_max_f32 v6, v6, v7
    s_mov_b64 exec, 0xffff
    ds_write_b32 v234, v6
    s_mov_b64 exec, -1
    v_mov_b32 v194, 0x3f803f80
    v_mov_b32 v195, 0x3f803f80
    v_mov_b32 v196, 0x3f803f80
    v_mov_b32 v197, 0x3f803f80
    s_waitcnt lgkmcnt(0)
    s_barrier
    ds_read_b128 v[150:153], v235
    ds_read_b128 v[154:157], v235 offset:16
    s_waitcnt lgkmcnt(1)
    v_max3_f32 v6, v150, v151, v152
    s_waitcnt lgkmcnt(0)
    v_max3_f32 v7, v153, v154, v155
    v_max3_f32 v6, v6, v156, v157
    v_max_f32 v6, v6, v7
    v_ceil_f32 v10, v6
    v_sub_f32 v18, v18, v10
    v_sub_f32 v19, v19, v10
    v_sub_f32 v20, v20, v10
    v_sub_f32 v21, v21, v10
    v_exp_f32 v18, v18
    v_exp_f32 v19, v19
    v_exp_f32 v20, v20
    v_exp_f32 v21, v21
    v_cvt_pk_bf16_f32 v18, v18, v19
    v_cvt_pk_bf16_f32 v19, v20, v21
    ds_write_b64 v233, v[18:19]
    s_waitcnt lgkmcnt(0)
    s_barrier
    ds_read_b128 v[158:161], v232 offset:0
    ds_read_b128 v[162:165], v232 offset:1024
    ds_read_b128 v[166:169], v232 offset:2048
    ds_read_b128 v[170:173], v232 offset:3072
    s_cmp_lg_u32 s3, 0
    s_cbranch_scc1 L_nol
    s_waitcnt lgkmcnt(3)
    v_mfma_f32_16x16x32_bf16 v[190:193], v[194:197], v[158:161], 0
    s_waitcnt lgkmcnt(2)
    v_mfma_f32_16x16x32_bf16 v[190:193], v[194:197], v[162:165], v[190:193]
    s_waitcnt lgkmcnt(1)
    v_mfma_f32_16x16x32_bf16 v[190:193], v[194:197], v[166:169], v[190:193]
    s_waitcnt lgkmcnt(0)
    v_mfma_f32_16x16x32_bf16 v[190:193], v[194:197], v[170:173], v[190:193]
L_nol:
    s_waitcnt lgkmcnt(3)
    v_mfma_f32_16x16x32_bf16 v[174:177], v[158:161], v[86:89], 0
    v_mfma_f32_16x16x32_bf16 v[178:181], v[158:161], v[102:105], 0
    v_mfma_f32_16x16x32_bf16 v[182:185], v[158:161], v[118:121], 0
    v_mfma_f32_16x16x32_bf16 v[186:189], v[158:161], v[134:137], 0
    s_mov_b64 exec, s[42:43]
    global_store_dwordx4 v236, v[10:13], s[40:41] sc1
    s_mov_b64 exec, -1
    s_waitcnt lgkmcnt(2)
    v_mfma_f32_16x16x32_bf16 v[174:177], v[162:165], v[90:93], v[174:177]
    v_mfma_f32_16x16x32_bf16 v[178:181], v[162:165], v[106:109], v[178:181]
    v_mfma_f32_16x16x32_bf16 v[182:185], v[162:165], v[122:125], v[182:185]
    v_mfma_f32_16x16x32_bf16 v[186:189], v[162:165], v[138:141], v[186:189]
    s_cmp_lg_u32 s3, 0
    s_cbranch_scc1 L_nol2
    v_mov_b32 v10, v190
    s_mov_b64 exec, 0xffff
    global_store_dwordx4 v226, v[10:13], s[40:41] offset:256 sc1
    s_mov_b64 exec, -1
L_nol2:
    s_waitcnt lgkmcnt(1)
    v_mfma_f32_16x16x32_bf16 v[174:177], v[166:169], v[94:97], v[174:177]
    v_mfma_f32_16x16x32_bf16 v[178:181], v[166:169], v[110:113], v[178:181]
    v_mfma_f32_16x16x32_bf16 v[182:185], v[166:169], v[126:129], v[182:185]
    v_mfma_f32_16x16x32_bf16 v[186:189], v[166:169], v[142:145], v[186:189]
    s_waitcnt lgkmcnt(0)
    v_mfma_f32_16x16x32_bf16 v[174:177], v[170:173], v[98:101], v[174:177]
    v_mfma_f32_16x16x32_bf16 v[178:181], v[170:173], v[114:117], v[178:181]
    v_mfma_f32_16x16x32_bf16 v[182:185], v[170:173], v[130:133], v[182:185]
    v_mfma_f32_16x16x32_bf16 v[186:189], v[170:173], v[146:149], v[186:189]
    s_nop 5
    v_cvt_pk_bf16_f32 v22, v174, v178
    v_cvt_pk_bf16_f32 v24, v175, v179
    v_cvt_pk_bf16_f32 v26, v176, v180
    v_cvt_pk_bf16_f32 v28, v177, v181
    v_cvt_pk_bf16_f32 v23, v182, v186
    global_store_dwordx2 v222, v[22:23], s[40:41] sc1
    v_cvt_pk_bf16_f32 v25, v183, v187
    global_store_dwordx2 v223, v[24:25], s[40:41] sc1
    v_cvt_pk_bf16_f32 v27, v184, v188
    global_store_dwordx2 v224, v[26:27], s[40:41] sc1
    v_cvt_pk_bf16_f32 v29, v185, v189
    global_store_dwordx2 v225, v[28:29], s[40:41] sc1
    s_lshr_b32 s8, s3, 1
    s_cmp_lg_u32 s8, 1
    s_cbranch_scc1 L_fin
    s_cmp_ge_u32 s69, 40
    s_cbranch_scc1 L_fin
    v_mul_u32_u24 v7, 20, v0
    global_load_dwordx4 v[86:89], v7, s[16:17]
    global_load_dword v90, v7, s[16:17] offset:16
    global_load_dwordx4 v[92:95], v7, s[34:35]
    global_load_dword v96, v7, s[34:35] offset:16
    s_lshr_b32 s8, s69, 3
    s_lshl_b32 s8, s8, 1
    s_and_b32 s9, s3, 1
    s_add_u32 s8, s8, s9
    s_mul_i32 s15, s4, 10
    s_add_u32 s15, s15, s8
    v_lshrrev_b32 v8, 1, v0
    v_and_b32 v6, 3, v8
    v_lshlrev_b32 v6, 11, v6
    v_lshl_add_u32 v6, v1, 14, v6
    v_and_b32 v7, 1, v0
    v_lshl_add_u32 v6, v7, 4, v6
    s_lshl_b32 s9, s8, 5
    s_and_b32 s8, s4, 3
    s_lshl_b32 s8, s8, 9
    s_add_u32 s9, s9, s8
    s_lshr_b32 s8, s4, 2
    s_lshl_b32 s8, s8, 13
    s_add_u32 s9, s9, s8
    s_xor_b32 s9, s9, s38
    s_add_u32 s9, s9, 524288
    v_add_u32 v214, s9, v6
    v_add_u32 v215, 131072, v214
    v_add_u32 v216, 262144, v214
    v_add_u32 v217, 393216, v214
    v_add_u32 v222, 524288, v214
    v_add_u32 v223, 524288, v215
    s_lshl_b32 s9, s15, 4
    v_lshl_add_u32 v218, v7, 3, s9
    v_lshl_add_u32 v218, v4, 1, v218
    v_and_b32 v219, 31, v0
    v_lshlrev_b32 v219, 8, v219
    v_lshrrev_b32 v6, 5, v0
    v_lshl_add_u32 v219, v6, 14, v219
    v_add_u32 v221, 4456448, v219
    s_and_b32 s9, s4, 3
    s_lshl_b32 s9, s9, 16
    s_lshr_b32 s8, s4, 2
    s_lshl_b32 s8, s8, 13
    s_add_u32 s9, s9, s8
    s_xor_b32 s9, s9, s38
    s_add_u32 s9, s9, 4194312
    v_add_u32 v219, s9, v219
    v_add_u32 v220, 32768, v219
    v_mov_b32 v106, 0
    v_mov_b32 v107, 0
    v_mov_b32 v108, 0
    v_mov_b32 v109, 0
    v_mov_b32 v9, 0
    s_waitcnt vmcnt(0)
    v_lshlrev_b32 v6, 16, v86
    v_lshlrev_b32 v7, 16, v92
    v_mul_f32 v6, v6, v7
    v_and_b32 v7, 0xffff0000, v86
    v_and_b32 v8, 0xffff0000, v92
    v_mul_f32 v7, v7, v8
    v_cvt_pk_bf16_f32 v6, v6, v7
    v_lshlrev_b32 v7, 16, v6
    v_and_b32 v6, 0xffff0000, v6
    v_add_f32 v9, v9, v7
    v_add_f32 v9, v9, v6
    v_lshlrev_b32 v6, 16, v87
    v_lshlrev_b32 v7, 16, v93
    v_mul_f32 v6, v6, v7
    v_and_b32 v7, 0xffff0000, v87
    v_and_b32 v8, 0xffff0000, v93
    v_mul_f32 v7, v7, v8
    v_cvt_pk_bf16_f32 v6, v6, v7
    v_lshlrev_b32 v7, 16, v6
    v_and_b32 v6, 0xffff0000, v6
    v_add_f32 v9, v9, v7
    v_add_f32 v9, v9, v6
    v_lshlrev_b32 v6, 16, v88
    v_lshlrev_b32 v7, 16, v94
    v_mul_f32 v6, v6, v7
    v_and_b32 v7, 0xffff0000, v88
    v_and_b32 v8, 0xffff0000, v94
    v_mul_f32 v7, v7, v8
    v_cvt_pk_bf16_f32 v6, v6, v7
    v_lshlrev_b32 v7, 16, v6
    v_and_b32 v6, 0xffff0000, v6
    v_add_f32 v9, v9, v7
    v_add_f32 v9, v9, v6
    v_lshlrev_b32 v6, 16, v89
    v_lshlrev_b32 v7, 16, v95
    v_mul_f32 v6, v6, v7
    v_and_b32 v7, 0xffff0000, v89
    v_and_b32 v8, 0xffff0000, v95
    v_mul_f32 v7, v7, v8
    v_cvt_pk_bf16_f32 v6, v6, v7
    v_lshlrev_b32 v7, 16, v6
    v_and_b32 v6, 0xffff0000, v6
    v_add_f32 v9, v9, v7
    v_add_f32 v9, v9, v6
    v_lshlrev_b32 v6, 16, v90
    v_lshlrev_b32 v7, 16, v96
    v_mul_f32 v6, v6, v7
    v_and_b32 v7, 0xffff0000, v90
    v_and_b32 v8, 0xffff0000, v96
    v_mul_f32 v7, v7, v8
    v_cvt_pk_bf16_f32 v6, v6, v7
    v_lshlrev_b32 v7, 16, v6
    v_and_b32 v6, 0xffff0000, v6
    v_add_f32 v9, v9, v7
    v_add_f32 v9, v9, v6
    s_nop 1
    v_add_f32_dpp v9, v9, v9 row_ror:1 row_mask:0xf bank_mask:0xf
    s_nop 1
    v_add_f32_dpp v9, v9, v9 row_ror:2 row_mask:0xf bank_mask:0xf
    s_nop 1
    v_add_f32_dpp v9, v9, v9 row_ror:4 row_mask:0xf bank_mask:0xf
    s_nop 1
    v_add_f32_dpp v9, v9, v9 row_ror:8 row_mask:0xf bank_mask:0xf
    v_mov_b32 v6, v9
    s_nop 1
    v_permlane16_swap_b32 v9, v6
    v_add_f32 v9, v9, v6
    v_mov_b32 v6, v9
    s_nop 1
    v_permlane32_swap_b32 v9, v6
    v_add_f32 v9, v9, v6
    v_cvt_pk_bf16_f32 v9, v9, v9
    v_and_b32 v9, 0xffff0000, v9
    v_mul_f32 v9, 0xbfb8aa3b, v9
    v_exp_f32 v9, v9
    s_nop 0
    v_add_f32 v9, 1.0, v9
    v_rcp_f32 v9, v9
    s_nop 0
    v_cvt_pk_bf16_f32 v98, v9, v9
    v_and_b32 v98, 0xffff0000, v98
    v_sub_f32 v99, 1.0, v98
    v_cvt_pk_bf16_f32 v99, v99, v99
    v_and_b32 v99, 0xffff0000, v99
    s_mov_b32 s13, 0
    s_mov_b64 s[72:73], -1
    s_mov_b64 s[74:75], -1
L_frp:
    s_mov_b64 exec, s[72:73]
    global_load_dwordx2 v[118:119], v219, s[40:41] sc1
    s_mov_b64 exec, s[74:75]
    global_load_dwordx2 v[120:121], v220, s[40:41] sc1
    s_mov_b64 exec, -1
    s_add_u32 s13, s13, 1
    s_waitcnt vmcnt(0)
    v_cmp_ne_u64 s[72:73], s[70:71], v[118:119]
    v_cmp_ne_u64 s[74:75], s[70:71], v[120:121]
    s_nop 0
    s_or_b64 vcc, s[72:73], s[74:75]
    s_cmp_gt_u32 s13, 200000
    s_cbranch_scc1 L_fro
    s_cbranch_vccnz L_frp
L_fro:
    global_load_dwordx4 v[102:105], v222, s[40:41] sc1
    s_mov_b32 exec_hi, 0xfff
    global_load_dwordx4 v[106:109], v223, s[40:41] sc1
    s_mov_b32 exec_hi, -1
    global_load_dwordx4 v[134:137], v214, s[40:41] sc1
    global_load_dwordx4 v[138:141], v215, s[40:41] sc1
    global_load_dwordx4 v[142:145], v216, s[40:41] sc1
    global_load_dwordx4 v[146:149], v217, s[40:41] sc1
    s_mov_b32 s13, 0
    s_branch L_pcc
L_pcp:
    s_mov_b64 exec, s[72:73]
    global_load_dwordx4 v[102:105], v222, s[40:41] sc1
    s_mov_b64 exec, s[74:75]
    global_load_dwordx4 v[106:109], v223, s[40:41] sc1
    s_mov_b64 exec, s[76:77]
    global_load_dwordx4 v[134:137], v214, s[40:41] sc1
    s_mov_b64 exec, s[66:67]
    global_load_dwordx4 v[138:141], v215, s[40:41] sc1
    s_mov_b64 exec, s[64:65]
    global_load_dwordx4 v[142:145], v216, s[40:41] sc1
    s_mov_b64 exec, s[62:63]
    global_load_dwordx4 v[146:149], v217, s[40:41] sc1
    s_mov_b64 exec, -1
L_pcc:
    s_add_u32 s13, s13, 1
    s_waitcnt vmcnt(5)
    v_max3_u32 v8, v102, v103, v104
    v_max_u32 v8, v8, v105
    v_cmp_eq_u32 s[72:73], -1, v8
    s_waitcnt vmcnt(4)
    v_max3_u32 v8, v106, v107, v108
    v_max_u32 v8, v8, v109
    v_cmp_eq_u32 s[74:75], -1, v8
    v_add_f32 v110, v102, v106
    v_add_f32 v111, v103, v107
    v_add_f32 v112, v104, v108
    v_add_f32 v113, v105, v109
    v_mul_f32 v110, v99, v110
    v_mul_f32 v111, v99, v111
    v_mul_f32 v112, v99, v112
    v_mul_f32 v113, v99, v113
    s_waitcnt vmcnt(3)
    v_max3_u32 v8, v134, v135, v136
    v_max_u32 v8, v8, v137
    v_cmp_eq_u32 s[76:77], -1, v8
    s_waitcnt vmcnt(2)
    v_max3_u32 v8, v138, v139, v140
    v_max_u32 v8, v8, v141
    v_cmp_eq_u32 s[66:67], -1, v8
    s_waitcnt vmcnt(1)
    v_max3_u32 v8, v142, v143, v144
    v_max_u32 v8, v8, v145
    v_cmp_eq_u32 s[64:65], -1, v8
    s_waitcnt vmcnt(0)
    v_max3_u32 v8, v146, v147, v148
    v_max_u32 v8, v8, v149
    v_cmp_eq_u32 s[62:63], -1, v8
    s_nop 0
    s_or_b64 vcc, s[72:73], s[74:75]
    s_or_b64 vcc, vcc, s[76:77]
    s_or_b64 vcc, vcc, s[66:67]
    s_or_b64 vcc, vcc, s[64:65]
    s_or_b64 vcc, vcc, s[62:63]
    s_cmp_gt_u32 s13, 200000
    s_cbranch_scc1 L_pco
    s_cbranch_vccnz L_pcp
L_pco:
    v_pk_add_f32 v[134:135], v[134:135], v[138:139]
    v_pk_add_f32 v[142:143], v[142:143], v[146:147]
    v_pk_add_f32 v[136:137], v[136:137], v[140:141]
    v_pk_add_f32 v[144:145], v[144:145], v[148:149]
    v_pk_add_f32 v[134:135], v[134:135], v[142:143]
    v_pk_add_f32 v[136:137], v[136:137], v[144:145]
    v_fmac_f32 v110, v98, v134
    v_fmac_f32 v111, v98, v135
    v_fmac_f32 v112, v98, v136
    v_fmac_f32 v113, v98, v137
    s_nop 0
    v_permlane32_swap_b32 v110, v112
    v_permlane32_swap_b32 v111, v113
    v_add_f32 v110, v110, v112
    v_add_f32 v111, v111, v113
    s_nop 1
    v_permlane16_swap_b32 v110, v111
    v_add_f32 v110, v110, v111
    s_nop 1
    v_add_f32_dpp v110, v110, v110 row_ror:8 row_mask:0xf bank_mask:0xf
    s_nop 1
    v_add_f32_dpp v110, v110, v110 row_ror:4 row_mask:0xf bank_mask:0xf
    s_nop 1
    v_add_f32_dpp v110, v110, v110 row_ror:2 row_mask:0xf bank_mask:0xf
    v_cvt_pk_bf16_f32 v110, v110, v110
    s_mov_b32 exec_lo, 0x30003
    s_mov_b32 exec_hi, 0x30003
    global_store_short v218, v110, s[36:37] sc1
    s_cmp_lg_u32 s15, 0
    s_cbranch_scc1 L_noep
    s_mov_b64 exec, 1
    v_mov_b32 v6, 4472832
    global_store_dwordx2 v6, v[12:13], s[40:41] sc1
L_noep:
    s_mov_b64 exec, -1
L_fin:
L_end:
    s_endpgm
    .fill 3600, 4, 0xbf800000
.section .rodata,"a"
.p2align 6
.amdhsa_kernel gated_mix__compressed_kv_cla__dense_activation_silu__decode_kernel
  .amdhsa_next_free_vgpr 256
  .amdhsa_next_free_sgpr 102
  .amdhsa_accum_offset 256
  .amdhsa_group_segment_fixed_size 0
  .amdhsa_kernarg_size 104
  .amdhsa_user_sgpr_count 2
  .amdhsa_user_sgpr_kernarg_segment_ptr 1
  .amdhsa_system_sgpr_workgroup_id_x 1
  .amdhsa_float_denorm_mode_32 3
  .amdhsa_float_denorm_mode_16_64 3
.end_amdhsa_kernel
```
